```python
import torch

def _softmax(x, axis=-1):
    return torch.softmax(x, dim=axis)
def _gelu(x):
    return torch.nn.functional.gelu(x, approximate="tanh")
def _silu(x):
    return torch.nn.functional.silu(x)
def _sigmoid(x):
    return torch.sigmoid(x)
def _layernorm(x, axis=-1, eps=1e-5):
    m = x.mean(dim=axis, keepdim=True)
    v = x.var(dim=axis, keepdim=True, unbiased=False)
    return (x - m) / torch.sqrt(v + eps)
def _scatter_add(tgt, idx, src, axis=0):
    return tgt.clone().index_add_(axis, idx, src)
def _segment_sum(src, seg, n):
    out = torch.zeros((n,) + src.shape[1:], dtype=src.dtype)
    return out.index_add_(0, seg, src)
def _pad(x, pw):
    flat = tuple(v for pair in reversed(pw) for v in pair)
    return torch.nn.functional.pad(x, flat)

kernel_name = 'parallel_sum__ssm_conv_s5__mixer_token_mlp__prompt'

def setup_inputs():

    _w = (lambda a: (lambda t: t.to(torch.bfloat16) if t.is_floating_point() else t)(torch.as_tensor(a)))
    def _A_setup():
        B, S, D = 1, 2048, 448
        P = D
        Lambda_re = -0.5 * (lambda _x: torch.exp(torch.as_tensor(_x)))((lambda *s: torch.randn(*s, dtype=torch.bfloat16) * 0.1)(P))
        Lambda_im = (lambda *s: torch.randn(*s, dtype=torch.bfloat16) * 0.4)(P) * 1.0
        B_re = (lambda *s: torch.randn(*s, dtype=torch.bfloat16) * 0.2)(P, D) * (D ** -0.5)
        B_im = (lambda *s: torch.randn(*s, dtype=torch.bfloat16) * 0.2)(P, D) * (D ** -0.5)
        C_re = (lambda *s: torch.randn(*s, dtype=torch.bfloat16) * 0.2)(D, P) * (P ** -0.5)
        C_im = (lambda *s: torch.randn(*s, dtype=torch.bfloat16) * 0.2)(D, P) * (P ** -0.5)
        log_dt = (lambda *s: torch.randn(*s, dtype=torch.bfloat16) * 0.1)(P) * 0.3 - 2.0
        Dskip = (lambda *s: torch.randn(*s, dtype=torch.bfloat16) * 0.05)(D)
        return {
            "x": _w((lambda *s: torch.randn(*s, dtype=torch.bfloat16) * 0.05)(B, S, D)),
            "Lambda_re": _w(Lambda_re),
            "Lambda_im": _w(Lambda_im),
            "B_re": _w(B_re),
            "B_im": _w(B_im),
            "C_re": _w(C_re),
            "C_im": _w(C_im),
            "log_dt": _w(log_dt),
            "Dskip": _w(Dskip),
        }
    _A_in = _A_setup()

    def _B_setup():
        B, S, D, F = 1, 2048, 448, 1792
        return {
            "x": _w((lambda *s: torch.randn(*s, dtype=torch.bfloat16) * 0.05)(B, S, D)),
            "w1": _w((lambda *s: torch.randn(*s, dtype=torch.bfloat16) * 0.8)(S, F) * (S ** -0.5)),
            "b1": _w((lambda *s: torch.randn(*s, dtype=torch.bfloat16) * 3.2)(F) * 0.02),
            "w2": _w((lambda *s: torch.randn(*s, dtype=torch.bfloat16) * 0.4)(F, S) * (F ** -0.5)),
            "b2": _w((lambda *s: torch.randn(*s, dtype=torch.bfloat16) * 1.6)(S) * 0.02),
        }
    _B_in = _B_setup()

    return {
        "A_x": _A_in["x"],
        "A_Lambda_re": _A_in["Lambda_re"],
        "A_Lambda_im": _A_in["Lambda_im"],
        "A_B_re": _A_in["B_re"],
        "A_B_im": _A_in["B_im"],
        "A_C_re": _A_in["C_re"],
        "A_C_im": _A_in["C_im"],
        "A_log_dt": _A_in["log_dt"],
        "A_Dskip": _A_in["Dskip"],
        "B_x": _B_in["x"],
        "B_w1": _B_in["w1"],
        "B_b1": _B_in["b1"],
        "B_w2": _B_in["w2"],
        "B_b2": _B_in["b2"],
    }

def reference(A_x, A_Lambda_re, A_Lambda_im, A_B_re, A_B_im, A_C_re, A_C_im, A_log_dt, A_Dskip, B_x, B_w1, B_b1, B_w2, B_b2):
    def _A_ref(x, Lambda_re, Lambda_im, B_re, B_im, C_re, C_im, log_dt, Dskip):
        Bsz, L, H = x.shape
        Lam = Lambda_re + 1j * Lambda_im
        Bmat = B_re + 1j * B_im
        Cmat = C_re + 1j * C_im
        dt = torch.exp(log_dt)
        Lam_bar = torch.exp(dt * Lam)
        B_bar = ((Lam_bar - 1.0) / Lam)[:, None] * Bmat
        Bu = torch.einsum("bld,pd->blp", x + 0j, B_bar)
        h = torch.zeros_like(Bu[:, 0, :])
        hs = []
        for t in range(L):
            h = Lam_bar[None, :] * h + Bu[:, t, :]
            hs.append(h)
        hseq = torch.stack(hs, 1)
        y = 2.0 * torch.einsum("blp,dp->bld", hseq, Cmat).real + x * Dskip[None, None, :]
        return y

    def _B_ref(x, w1, b1, w2, b2):
        B, S, D = x.shape
        h = _layernorm(x, axis=-1)
        u = torch.einsum("bsd,sf->bdf", h, w1) + b1
        u = _gelu(u)
        y = torch.einsum("bdf,fs->bds", u, w2) + b2
        return (lambda x, *d: x.permute(*d))(y, 0, 2, 1)

    x = A_x
    xn = _layernorm(x, axis=-1)
    return x + _A_ref(xn, A_Lambda_re, A_Lambda_im, A_B_re, A_B_im, A_C_re, A_C_im, A_log_dt, A_Dskip) + _B_ref(xn, B_w1, B_b1, B_w2, B_b2)
```

```asm
; @launch grid=(256,1,1) block=(512,1,1) lds=152064
.amdgcn_target "amdgcn-amd-amdhsa--gfx950"
.text
.globl parallel_sum__ssm_conv_s5__mixer_token_mlp__prompt_kernel
.p2align 8
.type parallel_sum__ssm_conv_s5__mixer_token_mlp__prompt_kernel,@function
parallel_sum__ssm_conv_s5__mixer_token_mlp__prompt_kernel:
  s_cmp_ge_u32 s2, 256
  s_cbranch_scc1 L_end
  s_load_dwordx16 s[16:31], s[0:1], 0
  s_load_dwordx2 s[32:33], s[0:1], 64
  s_load_dwordx8 s[36:43], s[0:1], 80
  s_load_dwordx4 s[44:47], s[0:1], 112
  s_load_dwordx2 s[48:49], s[0:1], 128
  v_lshrrev_b32 v2, 6, v0
  v_and_b32 v1, 63, v0
  v_readfirstlane_b32 s3, v2
  s_and_b32 s4, s2, 7
  s_lshr_b32 s5, s2, 3
  s_lshl_b32 s50, s2, 3
  s_add_u32 s50, s50, s3
  s_mul_i32 s50, s50, 896
  v_lshlrev_b32 v3, 4, v1
  v_add_u32 v3, s50, v3
  v_cmp_gt_u32 s[34:35], 56, v1
  v_mov_b32 v2, 2147483648
  v_mov_b32 v68, 0x3b124925
  v_cndmask_b32 v70, v2, v3, s[34:35]
  s_waitcnt lgkmcnt(0)
  s_mov_b32 s56, s16
  s_and_b32 s57, s17, 0xffff
  s_mov_b32 s58, 1835008
  s_mov_b32 s59, 0x20000
  buffer_load_dwordx4 v[4:7], v70, s[56:59], 0 offen
  s_or_b32 s50, s2, s3
  s_cmp_lg_u32 s50, 0
  s_cbranch_scc1 L_tag1
  s_memrealtime s[50:51]
  s_waitcnt lgkmcnt(0)
  s_or_b32 s50, s50, 1
  v_mov_b32 v250, 0
  v_mov_b32 v251, s50
  v_cmp_eq_u32 vcc, 0, v1
  s_and_saveexec_b64 s[50:51], vcc
  s_cbranch_execz L_tg22
  global_store_dword v250, v251, s[46:47] sc1
L_tg22:
  s_mov_b64 exec, s[50:51]
L_tag1:
  s_mov_b32 s52, s48
  s_and_b32 s53, s49, 0xffff
  s_mov_b32 s54, 13703168
  s_mov_b32 s55, 0x20000
  s_cmp_ge_u32 s2, 56
  s_cselect_b32 s50, 1, 0
  s_cselect_b32 s64, s28, s26
  s_cselect_b32 s65, s29, s27
  s_and_b32 s65, s65, 0xffff
  s_mov_b32 s66, 401408
  s_mov_b32 s67, 0x20000
  s_mul_i32 s51, s50, 56
  s_sub_u32 s8, s2, s51
  s_lshr_b32 s9, s8, 2
  s_mul_i32 s9, s9, 336
  s_add_u32 s9, s9, s51
  s_add_u32 s9, s9, 224
  s_lshl_b32 s9, s9, 9
  s_and_b32 s51, s8, 3
  s_lshl_b32 s51, s51, 7
  s_add_u32 s9, s9, s51
  s_add_u32 s9, s9, 3670016
  s_mul_i32 s8, s8, 7168
  v_lshrrev_b32 v82, 3, v0
  v_and_b32 v83, 7, v0
  v_mul_u32_u24 v84, 896, v83
  v_lshl_add_u32 v84, v82, 4, v84
  v_lshlrev_b32 v85, 9, v82
  v_lshl_add_u32 v85, v83, 4, v85
  v_cmp_gt_u32 vcc, 448, v0
  s_cmp_lt_u32 s2, 112
  s_cselect_b64 s[50:51], -1, 0
  v_cndmask_b32 v106, v2, v85, vcc
  v_cndmask_b32 v84, v2, v84, vcc
  v_cndmask_b32 v84, v2, v84, s[50:51]
  v_cndmask_b32 v85, v2, v106, s[50:51]
  buffer_load_dwordx4 v[88:91], v84, s[64:67], s8 offen
  s_mul_i32 s50, s3, 960
  v_lshlrev_b32 v69, 4, v1
  v_add_u32 v69, s50, v69
  v_and_b32 v20, 15, v1
  v_lshrrev_b32 v21, 2, v20
  v_mul_u32_u24 v21, 960, v21
  v_and_b32 v22, 0x1f0, v0
  v_and_b32 v23, 3, v20
  v_lshl_add_u32 v22, v23, 2, v22
  v_lshl_add_u32 v102, v22, 1, v21
  v_mul_u32_u24 v22, 960, v83
  v_lshl_add_u32 v103, v82, 4, v22
  v_lshrrev_b32 v22, 5, v0
  v_lshlrev_b32 v22, 17, v22
  v_and_b32 v23, 31, v0
  v_lshl_add_u32 v22, v23, 4, v22
  v_cmp_gt_u32 vcc, 448, v0
  s_lshl_b32 s12, s2, 9
  s_add_u32 s12, s12, 0
  v_cndmask_b32 v104, v2, v22, vcc
  s_lshr_b32 s11, s2, 2
  s_mul_i32 s11, s11, 28672
  s_and_b32 s50, s2, 3
  s_lshl_b32 s50, s50, 7
  s_add_u32 s11, s11, s50
  s_add_u32 s11, s11, 1835008
  s_waitcnt vmcnt(1)
  v_lshlrev_b32 v12, 16, v4
  v_and_b32 v13, 0xffff0000, v4
  v_lshlrev_b32 v14, 16, v5
  v_and_b32 v15, 0xffff0000, v5
  v_lshlrev_b32 v16, 16, v6
  v_and_b32 v17, 0xffff0000, v6
  v_lshlrev_b32 v18, 16, v7
  v_and_b32 v19, 0xffff0000, v7
  v_add_f32 v44, v12, v13
  v_add_f32 v45, v14, v15
  v_add_f32 v46, v16, v17
  v_add_f32 v47, v18, v19
  v_add_f32 v44, v44, v45
  v_add_f32 v46, v46, v47
  v_add_f32 v44, v44, v46
  v_cndmask_b32 v44, 0, v44, s[34:35]
  s_nop 1
  v_add_f32_dpp v44, v44, v44 row_shr:1 row_mask:0xf bank_mask:0xf bound_ctrl:0
  s_nop 1
  v_add_f32_dpp v44, v44, v44 row_shr:2 row_mask:0xf bank_mask:0xf bound_ctrl:0
  s_nop 1
  v_add_f32_dpp v44, v44, v44 row_shr:4 row_mask:0xf bank_mask:0xf bound_ctrl:0
  s_nop 1
  v_add_f32_dpp v44, v44, v44 row_shr:8 row_mask:0xf bank_mask:0xf bound_ctrl:0
  s_nop 1
  v_add_f32_dpp v44, v44, v44 row_bcast:15 row_mask:0xa bank_mask:0xf
  s_nop 1
  v_add_f32_dpp v44, v44, v44 row_bcast:31 row_mask:0xc bank_mask:0xf
  s_nop 0
  v_readlane_b32 s10, v44, 63
  s_nop 1
  v_mul_f32 v45, s10, v68
  v_pk_add_f32 v[28:29], v[12:13], v[44:45] op_sel:[0,1] op_sel_hi:[1,1] neg_lo:[0,1] neg_hi:[0,1]
  v_pk_add_f32 v[30:31], v[14:15], v[44:45] op_sel:[0,1] op_sel_hi:[1,1] neg_lo:[0,1] neg_hi:[0,1]
  v_pk_add_f32 v[32:33], v[16:17], v[44:45] op_sel:[0,1] op_sel_hi:[1,1] neg_lo:[0,1] neg_hi:[0,1]
  v_pk_add_f32 v[34:35], v[18:19], v[44:45] op_sel:[0,1] op_sel_hi:[1,1] neg_lo:[0,1] neg_hi:[0,1]
  v_pk_mul_f32 v[46:47], v[28:29], v[28:29]
  v_pk_fma_f32 v[46:47], v[30:31], v[30:31], v[46:47]
  v_pk_fma_f32 v[46:47], v[32:33], v[32:33], v[46:47]
  v_pk_fma_f32 v[46:47], v[34:35], v[34:35], v[46:47]
  v_add_f32 v44, v46, v47
  v_cndmask_b32 v44, 0, v44, s[34:35]
  s_nop 1
  v_add_f32_dpp v44, v44, v44 row_shr:1 row_mask:0xf bank_mask:0xf bound_ctrl:0
  s_nop 1
  v_add_f32_dpp v44, v44, v44 row_shr:2 row_mask:0xf bank_mask:0xf bound_ctrl:0
  s_nop 1
  v_add_f32_dpp v44, v44, v44 row_shr:4 row_mask:0xf bank_mask:0xf bound_ctrl:0
  s_nop 1
  v_add_f32_dpp v44, v44, v44 row_shr:8 row_mask:0xf bank_mask:0xf bound_ctrl:0
  s_nop 1
  v_add_f32_dpp v44, v44, v44 row_bcast:15 row_mask:0xa bank_mask:0xf
  s_nop 1
  v_add_f32_dpp v44, v44, v44 row_bcast:31 row_mask:0xc bank_mask:0xf
  s_nop 0
  v_readlane_b32 s10, v44, 63
  s_nop 1
  v_mul_f32 v44, s10, v68
  v_cvt_pk_bf16_f32 v46, v45, v44
  v_lshlrev_b32 v45, 16, v46
  v_and_b32 v44, 0xffff0000, v46
  v_add_f32 v44, 0x3727c5ac, v44
  v_pk_add_f32 v[28:29], v[12:13], v[44:45] op_sel:[0,1] op_sel_hi:[1,1] neg_lo:[0,1] neg_hi:[0,1]
  v_pk_add_f32 v[30:31], v[14:15], v[44:45] op_sel:[0,1] op_sel_hi:[1,1] neg_lo:[0,1] neg_hi:[0,1]
  v_pk_add_f32 v[32:33], v[16:17], v[44:45] op_sel:[0,1] op_sel_hi:[1,1] neg_lo:[0,1] neg_hi:[0,1]
  v_pk_add_f32 v[34:35], v[18:19], v[44:45] op_sel:[0,1] op_sel_hi:[1,1] neg_lo:[0,1] neg_hi:[0,1]
  v_cvt_pk_bf16_f32 v44, v44, v44
  v_and_b32 v44, 0xffff0000, v44
  v_sqrt_f32 v44, v44
  v_cvt_pk_bf16_f32 v52, v28, v29
  v_cvt_pk_bf16_f32 v53, v30, v31
  v_cvt_pk_bf16_f32 v54, v32, v33
  v_cvt_pk_bf16_f32 v55, v34, v35
  v_cvt_pk_bf16_f32 v44, v44, v44
  v_and_b32 v44, 0xffff0000, v44
  v_rcp_f32 v44, v44
  v_lshlrev_b32 v28, 16, v52
  v_and_b32 v29, 0xffff0000, v52
  v_lshlrev_b32 v30, 16, v53
  v_and_b32 v31, 0xffff0000, v53
  v_lshlrev_b32 v32, 16, v54
  v_and_b32 v33, 0xffff0000, v54
  v_lshlrev_b32 v34, 16, v55
  v_and_b32 v35, 0xffff0000, v55
  v_pk_mul_f32 v[28:29], v[28:29], v[44:45] op_sel_hi:[1,0]
  v_pk_mul_f32 v[30:31], v[30:31], v[44:45] op_sel_hi:[1,0]
  v_pk_mul_f32 v[32:33], v[32:33], v[44:45] op_sel_hi:[1,0]
  v_pk_mul_f32 v[34:35], v[34:35], v[44:45] op_sel_hi:[1,0]
  v_cvt_pk_bf16_f32 v52, v28, v29
  v_cvt_pk_bf16_f32 v53, v30, v31
  v_cvt_pk_bf16_f32 v54, v32, v33
  v_cvt_pk_bf16_f32 v55, v34, v35
  v_lshlrev_b32 v12, 16, v52
  v_and_b32 v13, 0xffff0000, v52
  v_lshlrev_b32 v14, 16, v53
  v_and_b32 v15, 0xffff0000, v53
  v_lshlrev_b32 v16, 16, v54
  v_and_b32 v17, 0xffff0000, v54
  v_lshlrev_b32 v18, 16, v55
  v_and_b32 v19, 0xffff0000, v55
  v_pk_add_f32 v[28:29], v[12:13], v[14:15]
  v_pk_mul_f32 v[30:31], v[12:13], v[12:13]
  v_pk_add_f32 v[32:33], v[16:17], v[18:19]
  v_pk_fma_f32 v[30:31], v[14:15], v[14:15], v[30:31]
  v_pk_add_f32 v[28:29], v[28:29], v[32:33]
  v_pk_fma_f32 v[30:31], v[16:17], v[16:17], v[30:31]
  v_add_f32 v44, v28, v29
  v_pk_fma_f32 v[30:31], v[18:19], v[18:19], v[30:31]
  v_cndmask_b32 v44, 0, v44, s[34:35]
  v_add_f32 v46, v30, v31
  v_cndmask_b32 v46, 0, v46, s[34:35]
  s_nop 1
  v_add_f32_dpp v44, v44, v44 row_shr:1 row_mask:0xf bank_mask:0xf bound_ctrl:0
  v_add_f32_dpp v46, v46, v46 row_shr:1 row_mask:0xf bank_mask:0xf bound_ctrl:0
  s_nop 0
  v_add_f32_dpp v44, v44, v44 row_shr:2 row_mask:0xf bank_mask:0xf bound_ctrl:0
  v_add_f32_dpp v46, v46, v46 row_shr:2 row_mask:0xf bank_mask:0xf bound_ctrl:0
  s_nop 0
  v_add_f32_dpp v44, v44, v44 row_shr:4 row_mask:0xf bank_mask:0xf bound_ctrl:0
  v_add_f32_dpp v46, v46, v46 row_shr:4 row_mask:0xf bank_mask:0xf bound_ctrl:0
  s_nop 0
  v_add_f32_dpp v44, v44, v44 row_shr:8 row_mask:0xf bank_mask:0xf bound_ctrl:0
  v_add_f32_dpp v46, v46, v46 row_shr:8 row_mask:0xf bank_mask:0xf bound_ctrl:0
  s_nop 0
  v_add_f32_dpp v44, v44, v44 row_bcast:15 row_mask:0xa bank_mask:0xf
  v_add_f32_dpp v46, v46, v46 row_bcast:15 row_mask:0xa bank_mask:0xf
  s_nop 0
  v_add_f32_dpp v44, v44, v44 row_bcast:31 row_mask:0xc bank_mask:0xf
  v_add_f32_dpp v46, v46, v46 row_bcast:31 row_mask:0xc bank_mask:0xf
  s_nop 0
  v_readlane_b32 s10, v44, 63
  v_readlane_b32 s13, v46, 63
  s_nop 1
  v_mul_f32 v45, s10, v68
  v_mul_f32 v44, s13, v68
  v_fma_f32 v44, -v45, v45, v44
  v_max_f32 v44, 0, v44
  v_cvt_pk_bf16_f32 v46, v45, v44
  v_lshlrev_b32 v45, 16, v46
  v_and_b32 v44, 0xffff0000, v46
  v_add_f32 v44, 0x3727c5ac, v44
  v_pk_add_f32 v[28:29], v[12:13], v[44:45] op_sel:[0,1] op_sel_hi:[1,1] neg_lo:[0,1] neg_hi:[0,1]
  v_pk_add_f32 v[30:31], v[14:15], v[44:45] op_sel:[0,1] op_sel_hi:[1,1] neg_lo:[0,1] neg_hi:[0,1]
  v_pk_add_f32 v[32:33], v[16:17], v[44:45] op_sel:[0,1] op_sel_hi:[1,1] neg_lo:[0,1] neg_hi:[0,1]
  v_pk_add_f32 v[34:35], v[18:19], v[44:45] op_sel:[0,1] op_sel_hi:[1,1] neg_lo:[0,1] neg_hi:[0,1]
  v_cvt_pk_bf16_f32 v44, v44, v44
  v_and_b32 v44, 0xffff0000, v44
  v_sqrt_f32 v44, v44
  v_cvt_pk_bf16_f32 v60, v28, v29
  v_cvt_pk_bf16_f32 v61, v30, v31
  v_cvt_pk_bf16_f32 v62, v32, v33
  v_cvt_pk_bf16_f32 v63, v34, v35
  v_cvt_pk_bf16_f32 v44, v44, v44
  v_and_b32 v44, 0xffff0000, v44
  v_rcp_f32 v44, v44
  v_lshlrev_b32 v28, 16, v60
  v_and_b32 v29, 0xffff0000, v60
  v_lshlrev_b32 v30, 16, v61
  v_and_b32 v31, 0xffff0000, v61
  v_lshlrev_b32 v32, 16, v62
  v_and_b32 v33, 0xffff0000, v62
  v_lshlrev_b32 v34, 16, v63
  v_and_b32 v35, 0xffff0000, v63
  v_pk_mul_f32 v[28:29], v[28:29], v[44:45] op_sel_hi:[1,0]
  v_pk_mul_f32 v[30:31], v[30:31], v[44:45] op_sel_hi:[1,0]
  v_pk_mul_f32 v[32:33], v[32:33], v[44:45] op_sel_hi:[1,0]
  v_pk_mul_f32 v[34:35], v[34:35], v[44:45] op_sel_hi:[1,0]
  v_cvt_pk_bf16_f32 v60, v28, v29
  v_cvt_pk_bf16_f32 v61, v30, v31
  v_cvt_pk_bf16_f32 v62, v32, v33
  v_cvt_pk_bf16_f32 v63, v34, v35
  s_mov_b64 exec, s[34:35]
  ds_write_b128 v69, v[52:55]
  ds_write_b128 v69, v[60:63] offset:7680
  s_mov_b64 exec, -1
  s_waitcnt lgkmcnt(0)
  s_barrier
  ds_read_b64_tr_b16 v[12:13], v102 offset:7680
  ds_read_b64_tr_b16 v[14:15], v102 offset:11520
  ds_read_b128 v[16:19], v103
  s_waitcnt lgkmcnt(1)
  buffer_store_dwordx4 v[12:15], v104, s[52:55], s12 offen sc1
  s_waitcnt lgkmcnt(0)
  buffer_store_dwordx4 v[16:19], v106, s[52:55], s11 offen sc1
  s_waitcnt vmcnt(2)
  buffer_store_dwordx4 v[88:91], v85, s[52:55], s9 offen sc1
  v_mov_b32 v250, 0
  global_load_dword v251, v250, s[46:47] sc1
  s_waitcnt vmcnt(1)
  s_barrier
  s_waitcnt vmcnt(0)
  s_mov_b32 s50, 0
L_tagw3:
  s_nop 0
  v_readfirstlane_b32 s75, v251
  s_nop 3
  s_cmp_lg_u32 s75, 0
  s_cbranch_scc1 L_tago4
  s_add_u32 s50, s50, 1
  s_cmp_ge_u32 s50, 131072
  s_cbranch_scc1 L_tago4
  s_sleep 2
  global_load_dword v251, v250, s[46:47] sc1
  s_waitcnt vmcnt(0)
  s_branch L_tagw3
L_tago4:
  s_cmp_lg_u32 s3, 0
  s_cbranch_scc1 L_sig5
  s_lshl_b32 s50, s2, 6
  s_add_u32 s50, s50, 13664256
  v_mov_b32 v252, s50
  v_mov_b32 v253, s75
  v_cmp_eq_u32 vcc, 0, v1
  s_and_saveexec_b64 s[50:51], vcc
  s_cbranch_execz L_sg26
  buffer_store_dword v253, v252, s[52:55], 0 offen sc1
L_sg26:
  s_mov_b64 exec, s[50:51]
L_sig5:
  s_cmp_ge_u32 s5, 25
  s_cbranch_scc1 L_bu
  s_cmp_ge_u32 s3, 4
  s_cbranch_scc1 L_helper
  s_mul_i32 s50, s4, 49
  s_add_u32 s51, s50, 50
  s_add_u32 s50, s50, 1
  s_lshr_b32 s50, s50, 1
  s_lshr_b32 s51, s51, 1
  s_add_u32 s50, s50, s5
  s_cmp_ge_u32 s50, s51
  s_cbranch_scc1 L_idle
  s_mul_hi_u32 s6, s50, 613566757
  s_mul_i32 s51, s6, 7
  s_sub_u32 s7, s50, s51
  s_lshl_b32 s13, s3, 13
  s_mul_i32 s8, s3, 1835008
  s_lshl_b32 s50, s6, 7
  s_add_u32 s8, s8, s50
  s_lshl_b32 s10, s7, 8
  s_lshl_b32 s50, s3, 5
  s_add_u32 s10, s10, s50
  s_lshl_b32 s10, s10, 10
  s_add_u32 s10, s10, 0
  v_lshrrev_b32 v2, 3, v1
  v_mul_u32_u24 v2, 3584, v2
  v_lshrrev_b32 v3, 4, v1
  v_and_b32 v3, 1, v3
  v_lshlrev_b32 v4, 2, v3
  v_and_b32 v5, 7, v1
  v_xor_b32 v4, v4, v5
  v_lshl_add_u32 v2, v4, 4, v2
  v_and_b32 v4, 1, v1
  v_lshrrev_b32 v16, 1, v1
  v_and_b32 v16, 1, v16
  v_lshl_add_u32 v4, v3, 1, v4
  s_lshl_b32 s50, s3, 1
  v_xor_b32 v14, s50, v4
  v_lshrrev_b32 v5, 3, v1
  v_and_b32 v5, 1, v5
  v_lshlrev_b32 v5, 2, v5
  v_xor_b32 v4, v14, v5
  v_lshlrev_b32 v6, 4, v4
  v_lshl_add_u32 v6, v16, 3, v6
  v_lshrrev_b32 v15, 2, v1
  v_and_b32 v15, 3, v15
  v_lshrrev_b32 v5, 5, v1
  v_lshl_add_u32 v4, v5, 3, v15
  v_lshl_add_u32 v6, v4, 7, v6
  v_add_u32 v6, s13, v6
  v_xor_b32 v7, 64, v6
  v_add_u32 v3, 27648, v2
  s_mov_b32 s56, s36
  s_and_b32 s57, s37, 0xffff
  s_mov_b32 s58, 7340032
  s_mov_b32 s59, 0x20000
  v_lshlrev_b32 v4, 4, v1
  v_add_u32 v5, 131072, v4
  v_lshrrev_b32 v12, 5, v1
  v_lshlrev_b32 v12, 4, v12
  s_lshl_b32 s50, s6, 7
  s_lshl_b32 s51, s3, 5
  s_add_u32 s50, s50, s51
  v_add_u32 v12, s50, v12
  global_load_dwordx4 v[8:11], v12, s[38:39]
  v_lshlrev_b32 v13, 4, v1
  s_xor_b32 s50, s3, 1
  s_lshl_b32 s51, s50, 2
  s_add_u32 s51, s51, s3
  s_lshl_b32 s51, s51, 12
  s_add_u32 s51, s51, 32768
  v_add_u32 v16, s51, v13
  s_lshl_b32 s51, s3, 2
  s_add_u32 s51, s51, s50
  s_lshl_b32 s51, s51, 12
  s_add_u32 s51, s51, 32768
  v_add_u32 v19, s51, v13
  s_xor_b32 s50, s3, 2
  s_lshl_b32 s51, s50, 2
  s_add_u32 s51, s51, s3
  s_lshl_b32 s51, s51, 12
  s_add_u32 s51, s51, 32768
  v_add_u32 v17, s51, v13
  s_lshl_b32 s51, s3, 2
  s_add_u32 s51, s51, s50
  s_lshl_b32 s51, s51, 12
  s_add_u32 s51, s51, 32768
  v_add_u32 v20, s51, v13
  s_xor_b32 s50, s3, 3
  s_lshl_b32 s51, s50, 2
  s_add_u32 s51, s51, s3
  s_lshl_b32 s51, s51, 12
  s_add_u32 s51, s51, 32768
  v_add_u32 v18, s51, v13
  s_lshl_b32 s51, s3, 2
  s_add_u32 s51, s51, s50
  s_lshl_b32 s51, s51, 12
  s_add_u32 s51, s51, 32768
  v_add_u32 v21, s51, v13
  s_add_u32 m0, s13, 0
  s_nop 0
  buffer_load_dwordx4 v2, s[56:59], s8 offen lds
  buffer_load_dwordx4 v3, s[56:59], s8 offen offset:1024 lds
  s_add_u32 s8, s8, 57344
  s_add_u32 m0, s13, 2048
  s_nop 0
  buffer_load_dwordx4 v2, s[56:59], s8 offen lds
  buffer_load_dwordx4 v3, s[56:59], s8 offen offset:1024 lds
  s_add_u32 s8, s8, 57344
  s_add_u32 m0, s13, 4096
  s_nop 0
  buffer_load_dwordx4 v2, s[56:59], s8 offen lds
  buffer_load_dwordx4 v3, s[56:59], s8 offen offset:1024 lds
  s_add_u32 s8, s8, 57344
  s_add_u32 m0, s13, 6144
  s_nop 0
  buffer_load_dwordx4 v2, s[56:59], s8 offen lds
  buffer_load_dwordx4 v3, s[56:59], s8 offen offset:1024 lds
  s_add_u32 s8, s8, 57344
  s_waitcnt vmcnt(6)
  s_sleep 1
  v_min_u32 v240, 63, v1
  v_lshlrev_b32 v240, 6, v240
  s_cmp_eq_u32 s3, 0
  s_mov_b32 s51, 2147483648
  s_cselect_b32 s50, 13664256, s51
  v_add_u32 v240, s50, v240
  buffer_load_dword v244, v240, s[52:55], 0 offen sc1
  v_add_u32 v245, 4096, v240
  buffer_load_dword v245, v245, s[52:55], 0 offen sc1
  v_add_u32 v246, 8192, v240
  buffer_load_dword v246, v246, s[52:55], 0 offen sc1
  v_add_u32 v247, 12288, v240
  buffer_load_dword v247, v247, s[52:55], 0 offen sc1
  s_waitcnt vmcnt(0)
  s_cmp_lg_u32 s3, 0
  s_cbranch_scc1 L_pco8
  s_mov_b32 s50, 0
L_pc7:
  v_xor_b32 v244, s75, v244
  v_xor_b32 v245, s75, v245
  v_or_b32 v244, v244, v245
  v_xor_b32 v246, s75, v246
  v_or_b32 v244, v244, v246
  v_xor_b32 v247, s75, v247
  v_or_b32 v244, v244, v247
  v_cmp_ne_u32 vcc, 0, v244
  s_add_u32 s50, s50, 1
  s_cmp_ge_u32 s50, 131072
  s_cbranch_scc1 L_pco8
  s_cbranch_vccz L_pco8
  s_sleep 4
  buffer_load_dword v244, v240, s[52:55], 0 offen sc1
  v_add_u32 v245, 4096, v240
  buffer_load_dword v245, v245, s[52:55], 0 offen sc1
  v_add_u32 v246, 8192, v240
  buffer_load_dword v246, v246, s[52:55], 0 offen sc1
  v_add_u32 v247, 12288, v240
  buffer_load_dword v247, v247, s[52:55], 0 offen sc1
  s_waitcnt vmcnt(0)
  s_branch L_pc7
L_pco8:
  s_barrier
  buffer_load_dwordx4 v[128:131], v4, s[52:55], s10 offen sc1
  buffer_load_dwordx4 v[132:135], v5, s[52:55], s10 offen sc1
  s_add_u32 s10, s10, 1024
  buffer_load_dwordx4 v[136:139], v4, s[52:55], s10 offen sc1
  buffer_load_dwordx4 v[140:143], v5, s[52:55], s10 offen sc1
  s_add_u32 s10, s10, 1024
  buffer_load_dwordx4 v[144:147], v4, s[52:55], s10 offen sc1
  buffer_load_dwordx4 v[148:151], v5, s[52:55], s10 offen sc1
  s_add_u32 s10, s10, 1024
  buffer_load_dwordx4 v[152:155], v4, s[52:55], s10 offen sc1
  buffer_load_dwordx4 v[156:159], v5, s[52:55], s10 offen sc1
  s_add_u32 s10, s10, 1024
  s_waitcnt vmcnt(6)
  ds_read_b64_tr_b16 v[32:33], v6 offset:0
  ds_read_b64_tr_b16 v[34:35], v6 offset:512
  ds_read_b64_tr_b16 v[36:37], v7 offset:0
  ds_read_b64_tr_b16 v[38:39], v7 offset:512
  s_waitcnt vmcnt(4) lgkmcnt(0)
  ds_read_b64_tr_b16 v[40:41], v6 offset:2048
  ds_read_b64_tr_b16 v[42:43], v6 offset:2560
  ds_read_b64_tr_b16 v[44:45], v7 offset:2048
  ds_read_b64_tr_b16 v[46:47], v7 offset:2560
  s_add_u32 m0, s13, 0
  s_nop 0
  buffer_load_dwordx4 v2, s[56:59], s8 offen lds
  buffer_load_dwordx4 v3, s[56:59], s8 offen offset:1024 lds
  s_add_u32 s8, s8, 57344
  v_mfma_f32_32x32x16_bf16 v[64:79], v[32:35], v[128:131], 0
  v_mfma_f32_32x32x16_bf16 v[80:95], v[32:35], v[132:135], 0
  v_mfma_f32_32x32x16_bf16 v[96:111], v[36:39], v[128:131], 0
  v_mfma_f32_32x32x16_bf16 v[112:127], v[36:39], v[132:135], 0
  buffer_load_dwordx4 v[128:131], v4, s[52:55], s10 offen sc1
  buffer_load_dwordx4 v[132:135], v5, s[52:55], s10 offen sc1
  s_add_u32 s10, s10, 1024
  s_waitcnt vmcnt(6) lgkmcnt(0)
  ds_read_b64_tr_b16 v[32:33], v6 offset:4096
  ds_read_b64_tr_b16 v[34:35], v6 offset:4608
  ds_read_b64_tr_b16 v[36:37], v7 offset:4096
  ds_read_b64_tr_b16 v[38:39], v7 offset:4608
  s_add_u32 m0, s13, 2048
  s_nop 0
  buffer_load_dwordx4 v2, s[56:59], s8 offen lds
  buffer_load_dwordx4 v3, s[56:59], s8 offen offset:1024 lds
  s_add_u32 s8, s8, 57344
  v_mfma_f32_32x32x16_bf16 v[64:79], v[40:43], v[136:139], v[64:79]
  v_mfma_f32_32x32x16_bf16 v[80:95], v[40:43], v[140:143], v[80:95]
  v_mfma_f32_32x32x16_bf16 v[96:111], v[44:47], v[136:139], v[96:111]
  v_mfma_f32_32x32x16_bf16 v[112:127], v[44:47], v[140:143], v[112:127]
  buffer_load_dwordx4 v[136:139], v4, s[52:55], s10 offen sc1
  buffer_load_dwordx4 v[140:143], v5, s[52:55], s10 offen sc1
  s_add_u32 s10, s10, 1024
  s_waitcnt vmcnt(8) lgkmcnt(0)
  ds_read_b64_tr_b16 v[40:41], v6 offset:6144
  ds_read_b64_tr_b16 v[42:43], v6 offset:6656
  ds_read_b64_tr_b16 v[44:45], v7 offset:6144
  ds_read_b64_tr_b16 v[46:47], v7 offset:6656
  s_add_u32 m0, s13, 4096
  s_nop 0
  buffer_load_dwordx4 v2, s[56:59], s8 offen lds
  buffer_load_dwordx4 v3, s[56:59], s8 offen offset:1024 lds
  s_add_u32 s8, s8, 57344
  v_mfma_f32_32x32x16_bf16 v[64:79], v[32:35], v[144:147], v[64:79]
  v_mfma_f32_32x32x16_bf16 v[80:95], v[32:35], v[148:151], v[80:95]
  v_mfma_f32_32x32x16_bf16 v[96:111], v[36:39], v[144:147], v[96:111]
  v_mfma_f32_32x32x16_bf16 v[112:127], v[36:39], v[148:151], v[112:127]
  buffer_load_dwordx4 v[144:147], v4, s[52:55], s10 offen sc1
  buffer_load_dwordx4 v[148:151], v5, s[52:55], s10 offen sc1
  s_add_u32 s10, s10, 1024
  s_waitcnt vmcnt(8) lgkmcnt(0)
  ds_read_b64_tr_b16 v[32:33], v6 offset:0
  ds_read_b64_tr_b16 v[34:35], v6 offset:512
  ds_read_b64_tr_b16 v[36:37], v7 offset:0
  ds_read_b64_tr_b16 v[38:39], v7 offset:512
  s_add_u32 m0, s13, 6144
  s_nop 0
  buffer_load_dwordx4 v2, s[56:59], s8 offen lds
  buffer_load_dwordx4 v3, s[56:59], s8 offen offset:1024 lds
  s_add_u32 s8, s8, 57344
  v_mfma_f32_32x32x16_bf16 v[64:79], v[40:43], v[152:155], v[64:79]
  v_mfma_f32_32x32x16_bf16 v[80:95], v[40:43], v[156:159], v[80:95]
  v_mfma_f32_32x32x16_bf16 v[96:111], v[44:47], v[152:155], v[96:111]
  v_mfma_f32_32x32x16_bf16 v[112:127], v[44:47], v[156:159], v[112:127]
  buffer_load_dwordx4 v[152:155], v4, s[52:55], s10 offen sc1
  buffer_load_dwordx4 v[156:159], v5, s[52:55], s10 offen sc1
  s_add_u32 s10, s10, 1024
  s_waitcnt vmcnt(8) lgkmcnt(0)
  ds_read_b64_tr_b16 v[40:41], v6 offset:2048
  ds_read_b64_tr_b16 v[42:43], v6 offset:2560
  ds_read_b64_tr_b16 v[44:45], v7 offset:2048
  ds_read_b64_tr_b16 v[46:47], v7 offset:2560
  s_add_u32 m0, s13, 0
  s_nop 0
  buffer_load_dwordx4 v2, s[56:59], s8 offen lds
  buffer_load_dwordx4 v3, s[56:59], s8 offen offset:1024 lds
  s_add_u32 s8, s8, 57344
  v_mfma_f32_32x32x16_bf16 v[64:79], v[32:35], v[128:131], v[64:79]
  v_mfma_f32_32x32x16_bf16 v[80:95], v[32:35], v[132:135], v[80:95]
  v_mfma_f32_32x32x16_bf16 v[96:111], v[36:39], v[128:131], v[96:111]
  v_mfma_f32_32x32x16_bf16 v[112:127], v[36:39], v[132:135], v[112:127]
  buffer_load_dwordx4 v[128:131], v4, s[52:55], s10 offen sc1
  buffer_load_dwordx4 v[132:135], v5, s[52:55], s10 offen sc1
  s_add_u32 s10, s10, 1024
  s_waitcnt vmcnt(8) lgkmcnt(0)
  ds_read_b64_tr_b16 v[32:33], v6 offset:4096
  ds_read_b64_tr_b16 v[34:35], v6 offset:4608
  ds_read_b64_tr_b16 v[36:37], v7 offset:4096
  ds_read_b64_tr_b16 v[38:39], v7 offset:4608
  s_add_u32 m0, s13, 2048
  s_nop 0
  buffer_load_dwordx4 v2, s[56:59], s8 offen lds
  buffer_load_dwordx4 v3, s[56:59], s8 offen offset:1024 lds
  s_add_u32 s8, s8, 57344
  v_mfma_f32_32x32x16_bf16 v[64:79], v[40:43], v[136:139], v[64:79]
  v_mfma_f32_32x32x16_bf16 v[80:95], v[40:43], v[140:143], v[80:95]
  v_mfma_f32_32x32x16_bf16 v[96:111], v[44:47], v[136:139], v[96:111]
  v_mfma_f32_32x32x16_bf16 v[112:127], v[44:47], v[140:143], v[112:127]
  buffer_load_dwordx4 v[136:139], v4, s[52:55], s10 offen sc1
  buffer_load_dwordx4 v[140:143], v5, s[52:55], s10 offen sc1
  s_add_u32 s10, s10, 1024
  s_waitcnt vmcnt(8) lgkmcnt(0)
  ds_read_b64_tr_b16 v[40:41], v6 offset:6144
  ds_read_b64_tr_b16 v[42:43], v6 offset:6656
  ds_read_b64_tr_b16 v[44:45], v7 offset:6144
  ds_read_b64_tr_b16 v[46:47], v7 offset:6656
  s_add_u32 m0, s13, 4096
  s_nop 0
  buffer_load_dwordx4 v2, s[56:59], s8 offen lds
  buffer_load_dwordx4 v3, s[56:59], s8 offen offset:1024 lds
  s_add_u32 s8, s8, 57344
  v_mfma_f32_32x32x16_bf16 v[64:79], v[32:35], v[144:147], v[64:79]
  v_mfma_f32_32x32x16_bf16 v[80:95], v[32:35], v[148:151], v[80:95]
  v_mfma_f32_32x32x16_bf16 v[96:111], v[36:39], v[144:147], v[96:111]
  v_mfma_f32_32x32x16_bf16 v[112:127], v[36:39], v[148:151], v[112:127]
  buffer_load_dwordx4 v[144:147], v4, s[52:55], s10 offen sc1
  buffer_load_dwordx4 v[148:151], v5, s[52:55], s10 offen sc1
  s_add_u32 s10, s10, 1024
  s_waitcnt vmcnt(8) lgkmcnt(0)
  ds_read_b64_tr_b16 v[32:33], v6 offset:0
  ds_read_b64_tr_b16 v[34:35], v6 offset:512
  ds_read_b64_tr_b16 v[36:37], v7 offset:0
  ds_read_b64_tr_b16 v[38:39], v7 offset:512
  s_add_u32 m0, s13, 6144
  s_nop 0
  buffer_load_dwordx4 v2, s[56:59], s8 offen lds
  buffer_load_dwordx4 v3, s[56:59], s8 offen offset:1024 lds
  s_add_u32 s8, s8, 57344
  v_mfma_f32_32x32x16_bf16 v[64:79], v[40:43], v[152:155], v[64:79]
  v_mfma_f32_32x32x16_bf16 v[80:95], v[40:43], v[156:159], v[80:95]
  v_mfma_f32_32x32x16_bf16 v[96:111], v[44:47], v[152:155], v[96:111]
  v_mfma_f32_32x32x16_bf16 v[112:127], v[44:47], v[156:159], v[112:127]
  buffer_load_dwordx4 v[152:155], v4, s[52:55], s10 offen sc1
  buffer_load_dwordx4 v[156:159], v5, s[52:55], s10 offen sc1
  s_add_u32 s10, s10, 1024
  s_waitcnt vmcnt(8) lgkmcnt(0)
  ds_read_b64_tr_b16 v[40:41], v6 offset:2048
  ds_read_b64_tr_b16 v[42:43], v6 offset:2560
  ds_read_b64_tr_b16 v[44:45], v7 offset:2048
  ds_read_b64_tr_b16 v[46:47], v7 offset:2560
  s_add_u32 m0, s13, 0
  s_nop 0
  buffer_load_dwordx4 v2, s[56:59], s8 offen lds
  buffer_load_dwordx4 v3, s[56:59], s8 offen offset:1024 lds
  s_add_u32 s8, s8, 57344
  v_mfma_f32_32x32x16_bf16 v[64:79], v[32:35], v[128:131], v[64:79]
  v_mfma_f32_32x32x16_bf16 v[80:95], v[32:35], v[132:135], v[80:95]
  v_mfma_f32_32x32x16_bf16 v[96:111], v[36:39], v[128:131], v[96:111]
  v_mfma_f32_32x32x16_bf16 v[112:127], v[36:39], v[132:135], v[112:127]
  buffer_load_dwordx4 v[128:131], v4, s[52:55], s10 offen sc1
  buffer_load_dwordx4 v[132:135], v5, s[52:55], s10 offen sc1
  s_add_u32 s10, s10, 1024
  s_waitcnt vmcnt(8) lgkmcnt(0)
  ds_read_b64_tr_b16 v[32:33], v6 offset:4096
  ds_read_b64_tr_b16 v[34:35], v6 offset:4608
  ds_read_b64_tr_b16 v[36:37], v7 offset:4096
  ds_read_b64_tr_b16 v[38:39], v7 offset:4608
  s_add_u32 m0, s13, 2048
  s_nop 0
  buffer_load_dwordx4 v2, s[56:59], s8 offen lds
  buffer_load_dwordx4 v3, s[56:59], s8 offen offset:1024 lds
  s_add_u32 s8, s8, 57344
  v_mfma_f32_32x32x16_bf16 v[64:79], v[40:43], v[136:139], v[64:79]
  v_mfma_f32_32x32x16_bf16 v[80:95], v[40:43], v[140:143], v[80:95]
  v_mfma_f32_32x32x16_bf16 v[96:111], v[44:47], v[136:139], v[96:111]
  v_mfma_f32_32x32x16_bf16 v[112:127], v[44:47], v[140:143], v[112:127]
  buffer_load_dwordx4 v[136:139], v4, s[52:55], s10 offen sc1
  buffer_load_dwordx4 v[140:143], v5, s[52:55], s10 offen sc1
  s_add_u32 s10, s10, 1024
  s_waitcnt vmcnt(8) lgkmcnt(0)
  ds_read_b64_tr_b16 v[40:41], v6 offset:6144
  ds_read_b64_tr_b16 v[42:43], v6 offset:6656
  ds_read_b64_tr_b16 v[44:45], v7 offset:6144
  ds_read_b64_tr_b16 v[46:47], v7 offset:6656
  s_add_u32 m0, s13, 4096
  s_nop 0
  buffer_load_dwordx4 v2, s[56:59], s8 offen lds
  buffer_load_dwordx4 v3, s[56:59], s8 offen offset:1024 lds
  s_add_u32 s8, s8, 57344
  v_mfma_f32_32x32x16_bf16 v[64:79], v[32:35], v[144:147], v[64:79]
  v_mfma_f32_32x32x16_bf16 v[80:95], v[32:35], v[148:151], v[80:95]
  v_mfma_f32_32x32x16_bf16 v[96:111], v[36:39], v[144:147], v[96:111]
  v_mfma_f32_32x32x16_bf16 v[112:127], v[36:39], v[148:151], v[112:127]
  buffer_load_dwordx4 v[144:147], v4, s[52:55], s10 offen sc1
  buffer_load_dwordx4 v[148:151], v5, s[52:55], s10 offen sc1
  s_add_u32 s10, s10, 1024
  s_waitcnt vmcnt(8) lgkmcnt(0)
  ds_read_b64_tr_b16 v[32:33], v6 offset:0
  ds_read_b64_tr_b16 v[34:35], v6 offset:512
  ds_read_b64_tr_b16 v[36:37], v7 offset:0
  ds_read_b64_tr_b16 v[38:39], v7 offset:512
  s_add_u32 m0, s13, 6144
  s_nop 0
  buffer_load_dwordx4 v2, s[56:59], s8 offen lds
  buffer_load_dwordx4 v3, s[56:59], s8 offen offset:1024 lds
  s_add_u32 s8, s8, 57344
  v_mfma_f32_32x32x16_bf16 v[64:79], v[40:43], v[152:155], v[64:79]
  v_mfma_f32_32x32x16_bf16 v[80:95], v[40:43], v[156:159], v[80:95]
  v_mfma_f32_32x32x16_bf16 v[96:111], v[44:47], v[152:155], v[96:111]
  v_mfma_f32_32x32x16_bf16 v[112:127], v[44:47], v[156:159], v[112:127]
  buffer_load_dwordx4 v[152:155], v4, s[52:55], s10 offen sc1
  buffer_load_dwordx4 v[156:159], v5, s[52:55], s10 offen sc1
  s_add_u32 s10, s10, 1024
  s_waitcnt vmcnt(8) lgkmcnt(0)
  ds_read_b64_tr_b16 v[40:41], v6 offset:2048
  ds_read_b64_tr_b16 v[42:43], v6 offset:2560
  ds_read_b64_tr_b16 v[44:45], v7 offset:2048
  ds_read_b64_tr_b16 v[46:47], v7 offset:2560
  s_add_u32 m0, s13, 0
  s_nop 0
  buffer_load_dwordx4 v2, s[56:59], s8 offen lds
  buffer_load_dwordx4 v3, s[56:59], s8 offen offset:1024 lds
  s_add_u32 s8, s8, 57344
  v_mfma_f32_32x32x16_bf16 v[64:79], v[32:35], v[128:131], v[64:79]
  v_mfma_f32_32x32x16_bf16 v[80:95], v[32:35], v[132:135], v[80:95]
  v_mfma_f32_32x32x16_bf16 v[96:111], v[36:39], v[128:131], v[96:111]
  v_mfma_f32_32x32x16_bf16 v[112:127], v[36:39], v[132:135], v[112:127]
  buffer_load_dwordx4 v[128:131], v4, s[52:55], s10 offen sc1
  buffer_load_dwordx4 v[132:135], v5, s[52:55], s10 offen sc1
  s_add_u32 s10, s10, 1024
  s_waitcnt vmcnt(8) lgkmcnt(0)
  ds_read_b64_tr_b16 v[32:33], v6 offset:4096
  ds_read_b64_tr_b16 v[34:35], v6 offset:4608
  ds_read_b64_tr_b16 v[36:37], v7 offset:4096
  ds_read_b64_tr_b16 v[38:39], v7 offset:4608
  s_add_u32 m0, s13, 2048
  s_nop 0
  buffer_load_dwordx4 v2, s[56:59], s8 offen lds
  buffer_load_dwordx4 v3, s[56:59], s8 offen offset:1024 lds
  s_add_u32 s8, s8, 57344
  v_mfma_f32_32x32x16_bf16 v[64:79], v[40:43], v[136:139], v[64:79]
  v_mfma_f32_32x32x16_bf16 v[80:95], v[40:43], v[140:143], v[80:95]
  v_mfma_f32_32x32x16_bf16 v[96:111], v[44:47], v[136:139], v[96:111]
  v_mfma_f32_32x32x16_bf16 v[112:127], v[44:47], v[140:143], v[112:127]
  buffer_load_dwordx4 v[136:139], v4, s[52:55], s10 offen sc1
  buffer_load_dwordx4 v[140:143], v5, s[52:55], s10 offen sc1
  s_add_u32 s10, s10, 1024
  s_waitcnt vmcnt(8) lgkmcnt(0)
  ds_read_b64_tr_b16 v[40:41], v6 offset:6144
  ds_read_b64_tr_b16 v[42:43], v6 offset:6656
  ds_read_b64_tr_b16 v[44:45], v7 offset:6144
  ds_read_b64_tr_b16 v[46:47], v7 offset:6656
  s_add_u32 m0, s13, 4096
  s_nop 0
  buffer_load_dwordx4 v2, s[56:59], s8 offen lds
  buffer_load_dwordx4 v3, s[56:59], s8 offen offset:1024 lds
  s_add_u32 s8, s8, 57344
  v_mfma_f32_32x32x16_bf16 v[64:79], v[32:35], v[144:147], v[64:79]
  v_mfma_f32_32x32x16_bf16 v[80:95], v[32:35], v[148:151], v[80:95]
  v_mfma_f32_32x32x16_bf16 v[96:111], v[36:39], v[144:147], v[96:111]
  v_mfma_f32_32x32x16_bf16 v[112:127], v[36:39], v[148:151], v[112:127]
  buffer_load_dwordx4 v[144:147], v4, s[52:55], s10 offen sc1
  buffer_load_dwordx4 v[148:151], v5, s[52:55], s10 offen sc1
  s_add_u32 s10, s10, 1024
  s_waitcnt vmcnt(8) lgkmcnt(0)
  ds_read_b64_tr_b16 v[32:33], v6 offset:0
  ds_read_b64_tr_b16 v[34:35], v6 offset:512
  ds_read_b64_tr_b16 v[36:37], v7 offset:0
  ds_read_b64_tr_b16 v[38:39], v7 offset:512
  s_add_u32 m0, s13, 6144
  s_nop 0
  buffer_load_dwordx4 v2, s[56:59], s8 offen lds
  buffer_load_dwordx4 v3, s[56:59], s8 offen offset:1024 lds
  s_add_u32 s8, s8, 57344
  v_mfma_f32_32x32x16_bf16 v[64:79], v[40:43], v[152:155], v[64:79]
  v_mfma_f32_32x32x16_bf16 v[80:95], v[40:43], v[156:159], v[80:95]
  v_mfma_f32_32x32x16_bf16 v[96:111], v[44:47], v[152:155], v[96:111]
  v_mfma_f32_32x32x16_bf16 v[112:127], v[44:47], v[156:159], v[112:127]
  buffer_load_dwordx4 v[152:155], v4, s[52:55], s10 offen sc1
  buffer_load_dwordx4 v[156:159], v5, s[52:55], s10 offen sc1
  s_add_u32 s10, s10, 1024
  s_waitcnt vmcnt(8) lgkmcnt(0)
  ds_read_b64_tr_b16 v[40:41], v6 offset:2048
  ds_read_b64_tr_b16 v[42:43], v6 offset:2560
  ds_read_b64_tr_b16 v[44:45], v7 offset:2048
  ds_read_b64_tr_b16 v[46:47], v7 offset:2560
  s_add_u32 m0, s13, 0
  s_nop 0
  buffer_load_dwordx4 v2, s[56:59], s8 offen lds
  buffer_load_dwordx4 v3, s[56:59], s8 offen offset:1024 lds
  s_add_u32 s8, s8, 57344
  v_mfma_f32_32x32x16_bf16 v[64:79], v[32:35], v[128:131], v[64:79]
  v_mfma_f32_32x32x16_bf16 v[80:95], v[32:35], v[132:135], v[80:95]
  v_mfma_f32_32x32x16_bf16 v[96:111], v[36:39], v[128:131], v[96:111]
  v_mfma_f32_32x32x16_bf16 v[112:127], v[36:39], v[132:135], v[112:127]
  buffer_load_dwordx4 v[128:131], v4, s[52:55], s10 offen sc1
  buffer_load_dwordx4 v[132:135], v5, s[52:55], s10 offen sc1
  s_add_u32 s10, s10, 1024
  s_waitcnt vmcnt(8) lgkmcnt(0)
  ds_read_b64_tr_b16 v[32:33], v6 offset:4096
  ds_read_b64_tr_b16 v[34:35], v6 offset:4608
  ds_read_b64_tr_b16 v[36:37], v7 offset:4096
  ds_read_b64_tr_b16 v[38:39], v7 offset:4608
  s_add_u32 m0, s13, 2048
  s_nop 0
  buffer_load_dwordx4 v2, s[56:59], s8 offen lds
  buffer_load_dwordx4 v3, s[56:59], s8 offen offset:1024 lds
  s_add_u32 s8, s8, 57344
  v_mfma_f32_32x32x16_bf16 v[64:79], v[40:43], v[136:139], v[64:79]
  v_mfma_f32_32x32x16_bf16 v[80:95], v[40:43], v[140:143], v[80:95]
  v_mfma_f32_32x32x16_bf16 v[96:111], v[44:47], v[136:139], v[96:111]
  v_mfma_f32_32x32x16_bf16 v[112:127], v[44:47], v[140:143], v[112:127]
  buffer_load_dwordx4 v[136:139], v4, s[52:55], s10 offen sc1
  buffer_load_dwordx4 v[140:143], v5, s[52:55], s10 offen sc1
  s_add_u32 s10, s10, 1024
  s_waitcnt vmcnt(8) lgkmcnt(0)
  ds_read_b64_tr_b16 v[40:41], v6 offset:6144
  ds_read_b64_tr_b16 v[42:43], v6 offset:6656
  ds_read_b64_tr_b16 v[44:45], v7 offset:6144
  ds_read_b64_tr_b16 v[46:47], v7 offset:6656
  s_add_u32 m0, s13, 4096
  s_nop 0
  buffer_load_dwordx4 v2, s[56:59], s8 offen lds
  buffer_load_dwordx4 v3, s[56:59], s8 offen offset:1024 lds
  s_add_u32 s8, s8, 57344
  v_mfma_f32_32x32x16_bf16 v[64:79], v[32:35], v[144:147], v[64:79]
  v_mfma_f32_32x32x16_bf16 v[80:95], v[32:35], v[148:151], v[80:95]
  v_mfma_f32_32x32x16_bf16 v[96:111], v[36:39], v[144:147], v[96:111]
  v_mfma_f32_32x32x16_bf16 v[112:127], v[36:39], v[148:151], v[112:127]
  buffer_load_dwordx4 v[144:147], v4, s[52:55], s10 offen sc1
  buffer_load_dwordx4 v[148:151], v5, s[52:55], s10 offen sc1
  s_add_u32 s10, s10, 1024
  s_waitcnt vmcnt(8) lgkmcnt(0)
  ds_read_b64_tr_b16 v[32:33], v6 offset:0
  ds_read_b64_tr_b16 v[34:35], v6 offset:512
  ds_read_b64_tr_b16 v[36:37], v7 offset:0
  ds_read_b64_tr_b16 v[38:39], v7 offset:512
  s_add_u32 m0, s13, 6144
  s_nop 0
  buffer_load_dwordx4 v2, s[56:59], s8 offen lds
  buffer_load_dwordx4 v3, s[56:59], s8 offen offset:1024 lds
  s_add_u32 s8, s8, 57344
  v_mfma_f32_32x32x16_bf16 v[64:79], v[40:43], v[152:155], v[64:79]
  v_mfma_f32_32x32x16_bf16 v[80:95], v[40:43], v[156:159], v[80:95]
  v_mfma_f32_32x32x16_bf16 v[96:111], v[44:47], v[152:155], v[96:111]
  v_mfma_f32_32x32x16_bf16 v[112:127], v[44:47], v[156:159], v[112:127]
  buffer_load_dwordx4 v[152:155], v4, s[52:55], s10 offen sc1
  buffer_load_dwordx4 v[156:159], v5, s[52:55], s10 offen sc1
  s_add_u32 s10, s10, 1024
  s_waitcnt vmcnt(8) lgkmcnt(0)
  ds_read_b64_tr_b16 v[40:41], v6 offset:2048
  ds_read_b64_tr_b16 v[42:43], v6 offset:2560
  ds_read_b64_tr_b16 v[44:45], v7 offset:2048
  ds_read_b64_tr_b16 v[46:47], v7 offset:2560
  s_add_u32 m0, s13, 0
  s_nop 0
  buffer_load_dwordx4 v2, s[56:59], s8 offen lds
  buffer_load_dwordx4 v3, s[56:59], s8 offen offset:1024 lds
  s_add_u32 s8, s8, 57344
  v_mfma_f32_32x32x16_bf16 v[64:79], v[32:35], v[128:131], v[64:79]
  v_mfma_f32_32x32x16_bf16 v[80:95], v[32:35], v[132:135], v[80:95]
  v_mfma_f32_32x32x16_bf16 v[96:111], v[36:39], v[128:131], v[96:111]
  v_mfma_f32_32x32x16_bf16 v[112:127], v[36:39], v[132:135], v[112:127]
  buffer_load_dwordx4 v[128:131], v4, s[52:55], s10 offen sc1
  buffer_load_dwordx4 v[132:135], v5, s[52:55], s10 offen sc1
  s_add_u32 s10, s10, 1024
  v_mov_b32 v22, 0xc0135761
  v_mov_b32 v23, 0xc0135761
  v_mov_b32 v24, 0xbdd2d3e8
  v_mov_b32 v25, 0xbdd2d3e8
  v_mov_b32 v26, 1.0
  v_mov_b32 v27, 1.0
  v_lshlrev_b32 v208, 16, v8
  v_and_b32 v209, 0xffff0000, v8
  v_lshlrev_b32 v210, 16, v9
  v_and_b32 v211, 0xffff0000, v9
  v_lshlrev_b32 v212, 16, v10
  v_and_b32 v213, 0xffff0000, v10
  v_lshlrev_b32 v214, 16, v11
  v_and_b32 v215, 0xffff0000, v11
  s_waitcnt vmcnt(8) lgkmcnt(0)
  ds_read_b64_tr_b16 v[32:33], v6 offset:4096
  ds_read_b64_tr_b16 v[34:35], v6 offset:4608
  ds_read_b64_tr_b16 v[36:37], v7 offset:4096
  ds_read_b64_tr_b16 v[38:39], v7 offset:4608
  s_add_u32 m0, s13, 2048
  s_nop 0
  buffer_load_dwordx4 v2, s[56:59], s8 offen lds
  buffer_load_dwordx4 v3, s[56:59], s8 offen offset:1024 lds
  s_add_u32 s8, s8, 57344
  v_mfma_f32_32x32x16_bf16 v[64:79], v[40:43], v[136:139], v[64:79]
  v_mfma_f32_32x32x16_bf16 v[80:95], v[40:43], v[140:143], v[80:95]
  v_mfma_f32_32x32x16_bf16 v[96:111], v[44:47], v[136:139], v[96:111]
  v_mfma_f32_32x32x16_bf16 v[112:127], v[44:47], v[140:143], v[112:127]
  buffer_load_dwordx4 v[136:139], v4, s[52:55], s10 offen sc1
  buffer_load_dwordx4 v[140:143], v5, s[52:55], s10 offen sc1
  s_add_u32 s10, s10, 1024
  s_waitcnt vmcnt(8) lgkmcnt(0)
  ds_read_b64_tr_b16 v[40:41], v6 offset:6144
  ds_read_b64_tr_b16 v[42:43], v6 offset:6656
  ds_read_b64_tr_b16 v[44:45], v7 offset:6144
  ds_read_b64_tr_b16 v[46:47], v7 offset:6656
  s_add_u32 m0, s13, 4096
  s_nop 0
  buffer_load_dwordx4 v2, s[56:59], s8 offen lds
  buffer_load_dwordx4 v3, s[56:59], s8 offen offset:1024 lds
  s_add_u32 s8, s8, 57344
  v_mfma_f32_32x32x16_bf16 v[64:79], v[32:35], v[144:147], v[64:79]
  v_mfma_f32_32x32x16_bf16 v[80:95], v[32:35], v[148:151], v[80:95]
  v_mfma_f32_32x32x16_bf16 v[96:111], v[36:39], v[144:147], v[96:111]
  v_mfma_f32_32x32x16_bf16 v[112:127], v[36:39], v[148:151], v[112:127]
  buffer_load_dwordx4 v[144:147], v4, s[52:55], s10 offen sc1
  buffer_load_dwordx4 v[148:151], v5, s[52:55], s10 offen sc1
  s_add_u32 s10, s10, 1024
  s_waitcnt vmcnt(8) lgkmcnt(0)
  ds_read_b64_tr_b16 v[32:33], v6 offset:0
  ds_read_b64_tr_b16 v[34:35], v6 offset:512
  ds_read_b64_tr_b16 v[36:37], v7 offset:0
  ds_read_b64_tr_b16 v[38:39], v7 offset:512
  s_add_u32 m0, s13, 6144
  s_nop 0
  buffer_load_dwordx4 v2, s[56:59], s8 offen lds
  buffer_load_dwordx4 v3, s[56:59], s8 offen offset:1024 lds
  s_add_u32 s8, s8, 57344
  v_mfma_f32_32x32x16_bf16 v[64:79], v[40:43], v[152:155], v[64:79]
  v_mfma_f32_32x32x16_bf16 v[80:95], v[40:43], v[156:159], v[80:95]
  v_mfma_f32_32x32x16_bf16 v[96:111], v[44:47], v[152:155], v[96:111]
  v_mfma_f32_32x32x16_bf16 v[112:127], v[44:47], v[156:159], v[112:127]
  buffer_load_dwordx4 v[152:155], v4, s[52:55], s10 offen sc1
  buffer_load_dwordx4 v[156:159], v5, s[52:55], s10 offen sc1
  s_add_u32 s10, s10, 1024
  s_waitcnt vmcnt(8) lgkmcnt(0)
  ds_read_b64_tr_b16 v[40:41], v6 offset:2048
  ds_read_b64_tr_b16 v[42:43], v6 offset:2560
  ds_read_b64_tr_b16 v[44:45], v7 offset:2048
  ds_read_b64_tr_b16 v[46:47], v7 offset:2560
  s_add_u32 m0, s13, 0
  s_nop 0
  buffer_load_dwordx4 v2, s[56:59], s8 offen lds
  buffer_load_dwordx4 v3, s[56:59], s8 offen offset:1024 lds
  s_add_u32 s8, s8, 57344
  v_mfma_f32_32x32x16_bf16 v[64:79], v[32:35], v[128:131], v[64:79]
  v_mfma_f32_32x32x16_bf16 v[80:95], v[32:35], v[132:135], v[80:95]
  v_mfma_f32_32x32x16_bf16 v[96:111], v[36:39], v[128:131], v[96:111]
  v_mfma_f32_32x32x16_bf16 v[112:127], v[36:39], v[132:135], v[112:127]
  buffer_load_dwordx4 v[128:131], v4, s[52:55], s10 offen sc1
  buffer_load_dwordx4 v[132:135], v5, s[52:55], s10 offen sc1
  s_add_u32 s10, s10, 1024
  s_waitcnt vmcnt(8) lgkmcnt(0)
  ds_read_b64_tr_b16 v[32:33], v6 offset:4096
  ds_read_b64_tr_b16 v[34:35], v6 offset:4608
  ds_read_b64_tr_b16 v[36:37], v7 offset:4096
  ds_read_b64_tr_b16 v[38:39], v7 offset:4608
  s_add_u32 m0, s13, 2048
  s_nop 0
  buffer_load_dwordx4 v2, s[56:59], s8 offen lds
  buffer_load_dwordx4 v3, s[56:59], s8 offen offset:1024 lds
  s_add_u32 s8, s8, 57344
  v_mfma_f32_32x32x16_bf16 v[64:79], v[40:43], v[136:139], v[64:79]
  v_mfma_f32_32x32x16_bf16 v[80:95], v[40:43], v[140:143], v[80:95]
  v_mfma_f32_32x32x16_bf16 v[96:111], v[44:47], v[136:139], v[96:111]
  v_mfma_f32_32x32x16_bf16 v[112:127], v[44:47], v[140:143], v[112:127]
  buffer_load_dwordx4 v[136:139], v4, s[52:55], s10 offen sc1
  buffer_load_dwordx4 v[140:143], v5, s[52:55], s10 offen sc1
  s_add_u32 s10, s10, 1024
  s_waitcnt vmcnt(8) lgkmcnt(0)
  ds_read_b64_tr_b16 v[40:41], v6 offset:6144
  ds_read_b64_tr_b16 v[42:43], v6 offset:6656
  ds_read_b64_tr_b16 v[44:45], v7 offset:6144
  ds_read_b64_tr_b16 v[46:47], v7 offset:6656
  s_add_u32 m0, s13, 4096
  s_nop 0
  buffer_load_dwordx4 v2, s[56:59], s8 offen lds
  buffer_load_dwordx4 v3, s[56:59], s8 offen offset:1024 lds
  s_add_u32 s8, s8, 57344
  v_mfma_f32_32x32x16_bf16 v[64:79], v[32:35], v[144:147], v[64:79]
  v_mfma_f32_32x32x16_bf16 v[80:95], v[32:35], v[148:151], v[80:95]
  v_mfma_f32_32x32x16_bf16 v[96:111], v[36:39], v[144:147], v[96:111]
  v_mfma_f32_32x32x16_bf16 v[112:127], v[36:39], v[148:151], v[112:127]
  buffer_load_dwordx4 v[144:147], v4, s[52:55], s10 offen sc1
  buffer_load_dwordx4 v[148:151], v5, s[52:55], s10 offen sc1
  s_add_u32 s10, s10, 1024
  s_waitcnt vmcnt(8) lgkmcnt(0)
  ds_read_b64_tr_b16 v[32:33], v6 offset:0
  ds_read_b64_tr_b16 v[34:35], v6 offset:512
  ds_read_b64_tr_b16 v[36:37], v7 offset:0
  ds_read_b64_tr_b16 v[38:39], v7 offset:512
  s_add_u32 m0, s13, 6144
  s_nop 0
  buffer_load_dwordx4 v2, s[56:59], s8 offen lds
  buffer_load_dwordx4 v3, s[56:59], s8 offen offset:1024 lds
  s_add_u32 s8, s8, 57344
  v_mfma_f32_32x32x16_bf16 v[64:79], v[40:43], v[152:155], v[64:79]
  v_mfma_f32_32x32x16_bf16 v[80:95], v[40:43], v[156:159], v[80:95]
  v_mfma_f32_32x32x16_bf16 v[96:111], v[44:47], v[152:155], v[96:111]
  v_mfma_f32_32x32x16_bf16 v[112:127], v[44:47], v[156:159], v[112:127]
  buffer_load_dwordx4 v[152:155], v4, s[52:55], s10 offen sc1
  buffer_load_dwordx4 v[156:159], v5, s[52:55], s10 offen sc1
  s_add_u32 s10, s10, 1024
  s_waitcnt vmcnt(8) lgkmcnt(0)
  ds_read_b64_tr_b16 v[40:41], v6 offset:2048
  ds_read_b64_tr_b16 v[42:43], v6 offset:2560
  ds_read_b64_tr_b16 v[44:45], v7 offset:2048
  ds_read_b64_tr_b16 v[46:47], v7 offset:2560
  v_mfma_f32_32x32x16_bf16 v[64:79], v[32:35], v[128:131], v[64:79]
  v_mfma_f32_32x32x16_bf16 v[80:95], v[32:35], v[132:135], v[80:95]
  v_mfma_f32_32x32x16_bf16 v[96:111], v[36:39], v[128:131], v[96:111]
  v_mfma_f32_32x32x16_bf16 v[112:127], v[36:39], v[132:135], v[112:127]
  s_waitcnt vmcnt(4) lgkmcnt(0)
  ds_read_b64_tr_b16 v[32:33], v6 offset:4096
  ds_read_b64_tr_b16 v[34:35], v6 offset:4608
  ds_read_b64_tr_b16 v[36:37], v7 offset:4096
  ds_read_b64_tr_b16 v[38:39], v7 offset:4608
  v_mfma_f32_32x32x16_bf16 v[64:79], v[40:43], v[136:139], v[64:79]
  v_mfma_f32_32x32x16_bf16 v[80:95], v[40:43], v[140:143], v[80:95]
  v_mfma_f32_32x32x16_bf16 v[96:111], v[44:47], v[136:139], v[96:111]
  v_mfma_f32_32x32x16_bf16 v[112:127], v[44:47], v[140:143], v[112:127]
  s_waitcnt vmcnt(0) lgkmcnt(0)
  ds_read_b64_tr_b16 v[40:41], v6 offset:6144
  ds_read_b64_tr_b16 v[42:43], v6 offset:6656
  ds_read_b64_tr_b16 v[44:45], v7 offset:6144
  ds_read_b64_tr_b16 v[46:47], v7 offset:6656
  v_mfma_f32_32x32x16_bf16 v[64:79], v[32:35], v[144:147], v[64:79]
  v_mfma_f32_32x32x16_bf16 v[80:95], v[32:35], v[148:151], v[80:95]
  v_mfma_f32_32x32x16_bf16 v[96:111], v[36:39], v[144:147], v[96:111]
  v_mfma_f32_32x32x16_bf16 v[112:127], v[36:39], v[148:151], v[112:127]
  s_waitcnt lgkmcnt(0)
  v_mfma_f32_32x32x16_bf16 v[64:79], v[40:43], v[152:155], v[64:79]
  v_mfma_f32_32x32x16_bf16 v[80:95], v[40:43], v[156:159], v[80:95]
  v_mfma_f32_32x32x16_bf16 v[96:111], v[44:47], v[152:155], v[96:111]
  v_mfma_f32_32x32x16_bf16 v[112:127], v[44:47], v[156:159], v[112:127]
  s_mov_b32 s68, s40
  s_and_b32 s69, s41, 0xffff
  s_mov_b32 s70, 7340032
  s_mov_b32 s71, 0x20000
  s_lshl_b32 s72, s4, 9
  s_lshl_b32 s50, s5, 6
  s_lshl_b32 s51, s3, 4
  s_add_u32 s50, s50, s51
  s_mul_i32 s50, s50, 4096
  s_add_u32 s50, s50, s72
  v_lshrrev_b32 v254, 2, v1
  v_mul_u32_u24 v254, 4096, v254
  v_and_b32 v253, 3, v1
  v_lshl_add_u32 v254, v253, 7, v254
  buffer_load_dword v255, v254, s[68:71], s50 offen
  s_cmp_lt_u32 s5, 3
  s_mov_b32 s51, 2147483648
  s_cselect_b32 s50, 6553600, s51
  s_lshl_b32 s51, s5, 2
  s_add_u32 s51, s51, s3
  s_mul_i32 s51, s51, 65536
  s_add_u32 s50, s50, s51
  s_add_u32 s50, s50, s72
  buffer_load_dword v255, v254, s[68:71], s50 offen
  s_nop 10
  ds_write_b128 v16, v[72:75] offset:0
  ds_write_b128 v16, v[76:79] offset:1024
  ds_write_b128 v16, v[88:91] offset:2048
  ds_write_b128 v16, v[92:95] offset:3072
  ds_write_b128 v17, v[96:99] offset:0
  ds_write_b128 v17, v[100:103] offset:1024
  ds_write_b128 v17, v[112:115] offset:2048
  ds_write_b128 v17, v[116:119] offset:3072
  ds_write_b128 v18, v[104:107] offset:0
  ds_write_b128 v18, v[108:111] offset:1024
  ds_write_b128 v18, v[120:123] offset:2048
  ds_write_b128 v18, v[124:127] offset:3072
  s_waitcnt lgkmcnt(0)
  s_barrier
  ds_read_b128 v[160:163], v19 offset:0
  ds_read_b128 v[164:167], v19 offset:1024
  ds_read_b128 v[168:171], v19 offset:2048
  ds_read_b128 v[172:175], v19 offset:3072
  ds_read_b128 v[176:179], v20 offset:0
  ds_read_b128 v[180:183], v20 offset:1024
  ds_read_b128 v[184:187], v20 offset:2048
  ds_read_b128 v[188:191], v20 offset:3072
  ds_read_b128 v[192:195], v21 offset:0
  ds_read_b128 v[196:199], v21 offset:1024
  ds_read_b128 v[200:203], v21 offset:2048
  ds_read_b128 v[204:207], v21 offset:3072
  s_waitcnt lgkmcnt(8)
  v_pk_add_f32 v[64:65], v[64:65], v[160:161]
  v_pk_add_f32 v[66:67], v[66:67], v[162:163]
  v_pk_add_f32 v[68:69], v[68:69], v[164:165]
  v_pk_add_f32 v[70:71], v[70:71], v[166:167]
  v_pk_add_f32 v[80:81], v[80:81], v[168:169]
  v_pk_add_f32 v[82:83], v[82:83], v[170:171]
  v_pk_add_f32 v[84:85], v[84:85], v[172:173]
  v_pk_add_f32 v[86:87], v[86:87], v[174:175]
  s_waitcnt lgkmcnt(4)
  v_pk_add_f32 v[64:65], v[64:65], v[176:177]
  v_pk_add_f32 v[66:67], v[66:67], v[178:179]
  v_pk_add_f32 v[68:69], v[68:69], v[180:181]
  v_pk_add_f32 v[70:71], v[70:71], v[182:183]
  v_pk_add_f32 v[80:81], v[80:81], v[184:185]
  v_pk_add_f32 v[82:83], v[82:83], v[186:187]
  v_pk_add_f32 v[84:85], v[84:85], v[188:189]
  v_pk_add_f32 v[86:87], v[86:87], v[190:191]
  s_waitcnt lgkmcnt(0)
  v_pk_add_f32 v[64:65], v[64:65], v[192:193]
  v_pk_add_f32 v[66:67], v[66:67], v[194:195]
  v_pk_add_f32 v[68:69], v[68:69], v[196:197]
  v_pk_add_f32 v[70:71], v[70:71], v[198:199]
  v_pk_add_f32 v[80:81], v[80:81], v[200:201]
  v_pk_add_f32 v[82:83], v[82:83], v[202:203]
  v_pk_add_f32 v[84:85], v[84:85], v[204:205]
  v_pk_add_f32 v[86:87], v[86:87], v[206:207]
  v_cvt_pk_bf16_f32 v160, v64, v65
  v_cvt_pk_bf16_f32 v161, v66, v67
  v_cvt_pk_bf16_f32 v162, v68, v69
  v_cvt_pk_bf16_f32 v163, v70, v71
  v_lshlrev_b32 v64, 16, v160
  v_and_b32 v65, 0xffff0000, v160
  v_lshlrev_b32 v66, 16, v161
  v_and_b32 v67, 0xffff0000, v161
  v_lshlrev_b32 v68, 16, v162
  v_and_b32 v69, 0xffff0000, v162
  v_lshlrev_b32 v70, 16, v163
  v_and_b32 v71, 0xffff0000, v163
  v_pk_add_f32 v[64:65], v[64:65], v[208:209]
  v_pk_add_f32 v[66:67], v[66:67], v[210:211]
  v_pk_add_f32 v[68:69], v[68:69], v[212:213]
  v_pk_add_f32 v[70:71], v[70:71], v[214:215]
  v_cvt_pk_bf16_f32 v160, v64, v65
  v_cvt_pk_bf16_f32 v161, v66, v67
  v_cvt_pk_bf16_f32 v162, v68, v69
  v_cvt_pk_bf16_f32 v163, v70, v71
  v_lshlrev_b32 v64, 16, v160
  v_and_b32 v65, 0xffff0000, v160
  v_lshlrev_b32 v66, 16, v161
  v_and_b32 v67, 0xffff0000, v161
  v_lshlrev_b32 v68, 16, v162
  v_and_b32 v69, 0xffff0000, v162
  v_lshlrev_b32 v70, 16, v163
  v_and_b32 v71, 0xffff0000, v163
  v_pk_mul_f32 v[160:161], v[64:65], v[64:65]
  v_pk_mul_f32 v[162:163], v[66:67], v[66:67]
  v_pk_mul_f32 v[164:165], v[68:69], v[68:69]
  v_pk_mul_f32 v[166:167], v[70:71], v[70:71]
  v_pk_fma_f32 v[160:161], v[160:161], v[24:25], v[22:23]
  v_pk_fma_f32 v[162:163], v[162:163], v[24:25], v[22:23]
  v_pk_fma_f32 v[164:165], v[164:165], v[24:25], v[22:23]
  v_pk_fma_f32 v[166:167], v[166:167], v[24:25], v[22:23]
  v_pk_mul_f32 v[160:161], v[160:161], v[64:65]
  v_pk_mul_f32 v[162:163], v[162:163], v[66:67]
  v_pk_mul_f32 v[164:165], v[164:165], v[68:69]
  v_pk_mul_f32 v[166:167], v[166:167], v[70:71]
  v_exp_f32 v160, v160
  v_exp_f32 v161, v161
  v_exp_f32 v162, v162
  v_exp_f32 v163, v163
  v_exp_f32 v164, v164
  v_exp_f32 v165, v165
  v_exp_f32 v166, v166
  v_exp_f32 v167, v167
  v_pk_add_f32 v[160:161], v[160:161], v[26:27]
  v_pk_add_f32 v[162:163], v[162:163], v[26:27]
  v_pk_add_f32 v[164:165], v[164:165], v[26:27]
  v_pk_add_f32 v[166:167], v[166:167], v[26:27]
  v_rcp_f32 v160, v160
  v_rcp_f32 v161, v161
  v_rcp_f32 v162, v162
  v_rcp_f32 v163, v163
  v_rcp_f32 v164, v164
  v_rcp_f32 v165, v165
  v_rcp_f32 v166, v166
  v_rcp_f32 v167, v167
  s_nop 0
  v_pk_mul_f32 v[64:65], v[64:65], v[160:161]
  v_pk_mul_f32 v[66:67], v[66:67], v[162:163]
  v_pk_mul_f32 v[68:69], v[68:69], v[164:165]
  v_pk_mul_f32 v[70:71], v[70:71], v[166:167]
  v_cvt_pk_bf16_f32 v168, v64, v65
  v_cvt_pk_bf16_f32 v169, v66, v67
  v_cvt_pk_bf16_f32 v170, v68, v69
  v_cvt_pk_bf16_f32 v171, v70, v71
  s_mul_i32 s74, s7, 336
  s_lshl_b32 s51, s6, 2
  s_add_u32 s74, s74, s51
  s_add_u32 s74, s74, s3
  s_lshl_b32 s74, s74, 10
  s_add_u32 s74, s74, 3670016
  buffer_store_dwordx4 v[168:171], v13, s[52:55], s74 offen sc1
  v_cvt_pk_bf16_f32 v176, v80, v81
  v_cvt_pk_bf16_f32 v177, v82, v83
  v_cvt_pk_bf16_f32 v178, v84, v85
  v_cvt_pk_bf16_f32 v179, v86, v87
  v_lshlrev_b32 v80, 16, v176
  v_and_b32 v81, 0xffff0000, v176
  v_lshlrev_b32 v82, 16, v177
  v_and_b32 v83, 0xffff0000, v177
  v_lshlrev_b32 v84, 16, v178
  v_and_b32 v85, 0xffff0000, v178
  v_lshlrev_b32 v86, 16, v179
  v_and_b32 v87, 0xffff0000, v179
  v_pk_add_f32 v[80:81], v[80:81], v[208:209]
  v_pk_add_f32 v[82:83], v[82:83], v[210:211]
  v_pk_add_f32 v[84:85], v[84:85], v[212:213]
  v_pk_add_f32 v[86:87], v[86:87], v[214:215]
  v_cvt_pk_bf16_f32 v176, v80, v81
  v_cvt_pk_bf16_f32 v177, v82, v83
  v_cvt_pk_bf16_f32 v178, v84, v85
  v_cvt_pk_bf16_f32 v179, v86, v87
  v_lshlrev_b32 v80, 16, v176
  v_and_b32 v81, 0xffff0000, v176
  v_lshlrev_b32 v82, 16, v177
  v_and_b32 v83, 0xffff0000, v177
  v_lshlrev_b32 v84, 16, v178
  v_and_b32 v85, 0xffff0000, v178
  v_lshlrev_b32 v86, 16, v179
  v_and_b32 v87, 0xffff0000, v179
  v_pk_mul_f32 v[176:177], v[80:81], v[80:81]
  v_pk_mul_f32 v[178:179], v[82:83], v[82:83]
  v_pk_mul_f32 v[180:181], v[84:85], v[84:85]
  v_pk_mul_f32 v[182:183], v[86:87], v[86:87]
  v_pk_fma_f32 v[176:177], v[176:177], v[24:25], v[22:23]
  v_pk_fma_f32 v[178:179], v[178:179], v[24:25], v[22:23]
  v_pk_fma_f32 v[180:181], v[180:181], v[24:25], v[22:23]
  v_pk_fma_f32 v[182:183], v[182:183], v[24:25], v[22:23]
  v_pk_mul_f32 v[176:177], v[176:177], v[80:81]
  v_pk_mul_f32 v[178:179], v[178:179], v[82:83]
  v_pk_mul_f32 v[180:181], v[180:181], v[84:85]
  v_pk_mul_f32 v[182:183], v[182:183], v[86:87]
  v_exp_f32 v176, v176
  v_exp_f32 v177, v177
  v_exp_f32 v178, v178
  v_exp_f32 v179, v179
  v_exp_f32 v180, v180
  v_exp_f32 v181, v181
  v_exp_f32 v182, v182
  v_exp_f32 v183, v183
  v_pk_add_f32 v[176:177], v[176:177], v[26:27]
  v_pk_add_f32 v[178:179], v[178:179], v[26:27]
  v_pk_add_f32 v[180:181], v[180:181], v[26:27]
  v_pk_add_f32 v[182:183], v[182:183], v[26:27]
  v_rcp_f32 v176, v176
  v_rcp_f32 v177, v177
  v_rcp_f32 v178, v178
  v_rcp_f32 v179, v179
  v_rcp_f32 v180, v180
  v_rcp_f32 v181, v181
  v_rcp_f32 v182, v182
  v_rcp_f32 v183, v183
  s_nop 0
  v_pk_mul_f32 v[80:81], v[80:81], v[176:177]
  v_pk_mul_f32 v[82:83], v[82:83], v[178:179]
  v_pk_mul_f32 v[84:85], v[84:85], v[180:181]
  v_pk_mul_f32 v[86:87], v[86:87], v[182:183]
  v_cvt_pk_bf16_f32 v184, v80, v81
  v_cvt_pk_bf16_f32 v185, v82, v83
  v_cvt_pk_bf16_f32 v186, v84, v85
  v_cvt_pk_bf16_f32 v187, v86, v87
  s_add_u32 s74, s74, 172032
  buffer_store_dwordx4 v[184:187], v13, s[52:55], s74 offen sc1
  s_lshl_b32 s74, s7, 5
  s_add_u32 s74, s74, s6
  s_waitcnt vmcnt(0)
  s_barrier
  s_cmp_lg_u32 s3, 0
  s_cbranch_scc1 L_sig9
  s_lshl_b32 s50, s74, 6
  s_add_u32 s50, s50, 13680640
  v_mov_b32 v252, s50
  v_mov_b32 v253, s75
  v_cmp_eq_u32 vcc, 0, v1
  s_and_saveexec_b64 s[50:51], vcc
  s_cbranch_execz L_sg210
  buffer_store_dword v253, v252, s[52:55], 0 offen sc1
L_sg210:
  s_mov_b64 exec, s[50:51]
L_sig9:
  s_branch L_g2
L_idle:
  v_min_u32 v240, 63, v1
  v_lshlrev_b32 v240, 6, v240
  s_cmp_eq_u32 s3, 0
  s_mov_b32 s51, 2147483648
  s_cselect_b32 s50, 13664256, s51
  v_add_u32 v240, s50, v240
  buffer_load_dword v244, v240, s[52:55], 0 offen sc1
  v_add_u32 v245, 4096, v240
  buffer_load_dword v245, v245, s[52:55], 0 offen sc1
  v_add_u32 v246, 8192, v240
  buffer_load_dword v246, v246, s[52:55], 0 offen sc1
  v_add_u32 v247, 12288, v240
  buffer_load_dword v247, v247, s[52:55], 0 offen sc1
  s_waitcnt vmcnt(0)
  s_cmp_lg_u32 s3, 0
  s_cbranch_scc1 L_pco12
  s_mov_b32 s50, 0
L_pc11:
  v_xor_b32 v244, s75, v244
  v_xor_b32 v245, s75, v245
  v_or_b32 v244, v244, v245
  v_xor_b32 v246, s75, v246
  v_or_b32 v244, v244, v246
  v_xor_b32 v247, s75, v247
  v_or_b32 v244, v244, v247
  v_cmp_ne_u32 vcc, 0, v244
  s_add_u32 s50, s50, 1
  s_cmp_ge_u32 s50, 131072
  s_cbranch_scc1 L_pco12
  s_cbranch_vccz L_pco12
  s_sleep 4
  buffer_load_dword v244, v240, s[52:55], 0 offen sc1
  v_add_u32 v245, 4096, v240
  buffer_load_dword v245, v245, s[52:55], 0 offen sc1
  v_add_u32 v246, 8192, v240
  buffer_load_dword v246, v246, s[52:55], 0 offen sc1
  v_add_u32 v247, 12288, v240
  buffer_load_dword v247, v247, s[52:55], 0 offen sc1
  s_waitcnt vmcnt(0)
  s_branch L_pc11
L_pco12:
  s_barrier
  s_mov_b32 s68, s40
  s_and_b32 s69, s41, 0xffff
  s_mov_b32 s70, 7340032
  s_mov_b32 s71, 0x20000
  s_lshl_b32 s72, s4, 9
  s_lshl_b32 s50, s5, 6
  s_lshl_b32 s51, s3, 4
  s_add_u32 s50, s50, s51
  s_mul_i32 s50, s50, 4096
  s_add_u32 s50, s50, s72
  v_lshrrev_b32 v254, 2, v1
  v_mul_u32_u24 v254, 4096, v254
  v_and_b32 v253, 3, v1
  v_lshl_add_u32 v254, v253, 7, v254
  buffer_load_dword v255, v254, s[68:71], s50 offen
  s_cmp_lt_u32 s5, 3
  s_mov_b32 s51, 2147483648
  s_cselect_b32 s50, 6553600, s51
  s_lshl_b32 s51, s5, 2
  s_add_u32 s51, s51, s3
  s_mul_i32 s51, s51, 65536
  s_add_u32 s50, s50, s51
  s_add_u32 s50, s50, s72
  buffer_load_dword v255, v254, s[68:71], s50 offen
  s_branch L_g2
L_bu:
  s_mov_b32 s6, s4
  s_sub_u32 s7, s5, 25
  s_and_b32 s72, s3, 3
  s_cmp_lt_u32 s72, 2
  s_cselect_b32 s60, s22, s24
  s_cselect_b32 s61, s23, s25
  s_and_b32 s61, s61, 0xffff
  s_mov_b32 s62, 401408
  s_mov_b32 s63, 0x20000
  v_lshrrev_b32 v4, 3, v1
  v_lshrrev_b32 v5, 1, v4
  v_and_b32 v6, 7, v1
  v_xor_b32 v6, v6, v5
  v_mul_u32_u24 v4, 896, v4
  v_lshl_add_u32 v22, v6, 4, v4
  v_xor_b32 v6, 4, v6
  v_lshl_add_u32 v23, v6, 4, v4
  s_lshl_b32 s73, s7, 6
  s_and_b32 s50, s72, 1
  s_lshl_b32 s50, s50, 5
  s_add_u32 s73, s73, s50
  s_lshr_b32 s51, s3, 2
  s_lshl_b32 s50, s51, 4
  s_add_u32 s73, s73, s50
  s_mul_i32 s73, s73, 896
  s_lshl_b32 s100, s72, 12
  s_lshl_b32 s50, s51, 11
  s_add_u32 s100, s100, s50
  s_add_u32 s100, s100, 32768
  v_and_b32 v2, 31, v1
  s_lshl_b32 s50, s7, 6
  v_add_u32 v3, s50, v2
  v_lshlrev_b32 v3, 1, v3
  global_load_ushort v14, v3, s[18:19] offset:0
  global_load_ushort v15, v3, s[20:21] offset:0
  global_load_ushort v16, v3, s[30:31] offset:0
  global_load_ushort v17, v3, s[18:19] offset:64
  global_load_ushort v18, v3, s[20:21] offset:64
  global_load_ushort v19, v3, s[30:31] offset:64
  s_add_u32 s15, s7, 0
  s_cmp_ge_u32 s15, 7
  s_cselect_b32 s51, 7, 0
  s_sub_u32 s15, s15, s51
  s_lshl_b32 s51, s15, 14
  s_add_u32 m0, s100, s51
  s_lshl_b32 s15, s15, 7
  s_add_u32 s15, s15, s73
  buffer_load_dwordx4 v22, s[60:63], s15 offen lds
  s_add_u32 m0, m0, 1024
  s_add_u32 s15, s15, 7168
  buffer_load_dwordx4 v23, s[60:63], s15 offen lds
  s_add_u32 s15, s7, 1
  s_cmp_ge_u32 s15, 7
  s_cselect_b32 s51, 7, 0
  s_sub_u32 s15, s15, s51
  s_lshl_b32 s51, s15, 14
  s_add_u32 m0, s100, s51
  s_lshl_b32 s15, s15, 7
  s_add_u32 s15, s15, s73
  buffer_load_dwordx4 v22, s[60:63], s15 offen lds
  s_add_u32 m0, m0, 1024
  s_add_u32 s15, s15, 7168
  buffer_load_dwordx4 v23, s[60:63], s15 offen lds
  s_add_u32 s15, s7, 2
  s_cmp_ge_u32 s15, 7
  s_cselect_b32 s51, 7, 0
  s_sub_u32 s15, s15, s51
  s_lshl_b32 s51, s15, 14
  s_add_u32 m0, s100, s51
  s_lshl_b32 s15, s15, 7
  s_add_u32 s15, s15, s73
  buffer_load_dwordx4 v22, s[60:63], s15 offen lds
  s_add_u32 m0, m0, 1024
  s_add_u32 s15, s15, 7168
  buffer_load_dwordx4 v23, s[60:63], s15 offen lds
  s_add_u32 s15, s7, 3
  s_cmp_ge_u32 s15, 7
  s_cselect_b32 s51, 7, 0
  s_sub_u32 s15, s15, s51
  s_lshl_b32 s51, s15, 14
  s_add_u32 m0, s100, s51
  s_lshl_b32 s15, s15, 7
  s_add_u32 s15, s15, s73
  buffer_load_dwordx4 v22, s[60:63], s15 offen lds
  s_add_u32 m0, m0, 1024
  s_add_u32 s15, s15, 7168
  buffer_load_dwordx4 v23, s[60:63], s15 offen lds
  s_add_u32 s15, s7, 4
  s_cmp_ge_u32 s15, 7
  s_cselect_b32 s51, 7, 0
  s_sub_u32 s15, s15, s51
  s_lshl_b32 s51, s15, 14
  s_add_u32 m0, s100, s51
  s_lshl_b32 s15, s15, 7
  s_add_u32 s15, s15, s73
  buffer_load_dwordx4 v22, s[60:63], s15 offen lds
  s_add_u32 m0, m0, 1024
  s_add_u32 s15, s15, 7168
  buffer_load_dwordx4 v23, s[60:63], s15 offen lds
  s_add_u32 s15, s7, 5
  s_cmp_ge_u32 s15, 7
  s_cselect_b32 s51, 7, 0
  s_sub_u32 s15, s15, s51
  s_lshl_b32 s51, s15, 14
  s_add_u32 m0, s100, s51
  s_lshl_b32 s15, s15, 7
  s_add_u32 s15, s15, s73
  buffer_load_dwordx4 v22, s[60:63], s15 offen lds
  s_add_u32 m0, m0, 1024
  s_add_u32 s15, s15, 7168
  buffer_load_dwordx4 v23, s[60:63], s15 offen lds
  s_add_u32 s15, s7, 6
  s_cmp_ge_u32 s15, 7
  s_cselect_b32 s51, 7, 0
  s_sub_u32 s15, s15, s51
  s_lshl_b32 s51, s15, 14
  s_add_u32 m0, s100, s51
  s_lshl_b32 s15, s15, 7
  s_add_u32 s15, s15, s73
  buffer_load_dwordx4 v22, s[60:63], s15 offen lds
  s_add_u32 m0, m0, 1024
  s_add_u32 s15, s15, 7168
  buffer_load_dwordx4 v23, s[60:63], s15 offen lds
  v_and_b32 v4, 0x13, v1
  v_lshrrev_b32 v5, 1, v1
  v_and_b32 v5, 4, v5
  v_or_b32 v4, v4, v5
  v_lshlrev_b32 v5, 1, v1
  v_and_b32 v5, 8, v5
  v_or_b32 v4, v4, v5
  v_lshlrev_b32 v4, 4, v4
  v_lshrrev_b32 v5, 5, v1
  v_lshl_add_u32 v24, v5, 9, v4
  v_lshrrev_b32 v4, 1, v2
  v_and_b32 v4, 7, v4
  v_xor_b32 v4, v4, v5
  v_lshlrev_b32 v6, 7, v2
  s_lshl_b32 s50, s7, 14
  s_add_u32 s50, s50, 32768
  v_add_u32 v6, s50, v6
  v_xor_b32 v7, 0, v4
  v_lshl_add_u32 v26, v7, 4, v6
  v_xor_b32 v7, 2, v4
  v_lshl_add_u32 v27, v7, 4, v6
  v_xor_b32 v7, 4, v4
  v_lshl_add_u32 v28, v7, 4, v6
  v_xor_b32 v7, 6, v4
  v_lshl_add_u32 v29, v7, 4, v6
  s_lshl_b32 s101, s6, 3
  s_add_u32 s101, s101, s3
  s_mul_i32 s101, s101, 28672
  s_add_u32 s101, s101, 1835008
  s_waitcnt vmcnt(14)
  v_lshlrev_b32 v14, 16, v14
  v_lshlrev_b32 v15, 16, v15
  v_lshlrev_b32 v16, 16, v16
  v_mul_f32 v4, 0x3fb8aa3b, v16
  v_exp_f32 v4, v4
  s_nop 0
  v_cvt_pk_bf16_f32 v4, v4, v4
  v_and_b32 v4, 0xffff0000, v4
  v_mul_f32 v5, v4, v14
  v_mul_f32 v6, v4, v15
  v_mul_f32 v5, 0x3fb8aa3b, v5
  v_mul_f32 v6, 0x3e22f983, v6
  v_exp_f32 v5, v5
  v_rndne_f32 v4, v6
  v_sub_f32 v6, v6, v4
  v_cos_f32 v96, v6
  v_sin_f32 v97, v6
  s_nop 0
  v_mul_f32 v96, v5, v96
  v_mul_f32 v97, v5, v97
  v_add_f32 v7, -1.0, v96
  v_mul_f32 v8, v14, v14
  v_fmac_f32 v8, v15, v15
  v_rcp_f32 v8, v8
  v_mul_f32 v104, v7, v14
  v_fmac_f32 v104, v97, v15
  v_mul_f32 v105, v97, v14
  v_fma_f32 v105, -v7, v15, v105
  v_add_f32 v8, v8, v8
  v_mul_f32 v104, v104, v8
  v_mul_f32 v105, v105, v8
  v_sub_f32 v106, 0, v97
  v_mov_b32 v107, v97
  v_mov_b32 v4, v96
  v_mov_b32 v5, v97
  v_mul_f32 v6, v5, v5
  v_mul_f32 v7, v4, v5
  v_fma_f32 v4, v4, v4, -v6
  v_add_f32 v5, v7, v7
  v_mul_f32 v6, v5, v5
  v_mul_f32 v7, v4, v5
  v_fma_f32 v4, v4, v4, -v6
  v_add_f32 v5, v7, v7
  v_mul_f32 v6, v5, v5
  v_mul_f32 v7, v4, v5
  v_fma_f32 v4, v4, v4, -v6
  v_add_f32 v5, v7, v7
  v_mov_b32 v98, v4
  v_mov_b32 v99, v5
  v_mul_f32 v6, v5, v5
  v_mul_f32 v7, v4, v5
  v_fma_f32 v4, v4, v4, -v6
  v_add_f32 v5, v7, v7
  v_mul_f32 v6, v5, v5
  v_mul_f32 v7, v4, v5
  v_fma_f32 v4, v4, v4, -v6
  v_add_f32 v5, v7, v7
  v_mov_b32 v100, v4
  v_mov_b32 v101, v5
  v_mul_f32 v6, v5, v5
  v_mul_f32 v7, v4, v5
  v_fma_f32 v4, v4, v4, -v6
  v_add_f32 v5, v7, v7
  v_mul_f32 v6, v5, v5
  v_mul_f32 v7, v4, v5
  v_fma_f32 v4, v4, v4, -v6
  v_add_f32 v5, v7, v7
  v_mul_f32 v6, v5, v5
  v_mul_f32 v7, v4, v5
  v_fma_f32 v4, v4, v4, -v6
  v_add_f32 v5, v7, v7
  v_mov_b32 v102, v4
  v_mov_b32 v103, v5
  v_lshlrev_b32 v17, 16, v17
  v_lshlrev_b32 v18, 16, v18
  v_lshlrev_b32 v19, 16, v19
  v_mul_f32 v4, 0x3fb8aa3b, v19
  v_exp_f32 v4, v4
  s_nop 0
  v_cvt_pk_bf16_f32 v4, v4, v4
  v_and_b32 v4, 0xffff0000, v4
  v_mul_f32 v5, v4, v17
  v_mul_f32 v6, v4, v18
  v_mul_f32 v5, 0x3fb8aa3b, v5
  v_mul_f32 v6, 0x3e22f983, v6
  v_exp_f32 v5, v5
  v_rndne_f32 v4, v6
  v_sub_f32 v6, v6, v4
  v_cos_f32 v108, v6
  v_sin_f32 v109, v6
  s_nop 0
  v_mul_f32 v108, v5, v108
  v_mul_f32 v109, v5, v109
  v_add_f32 v7, -1.0, v108
  v_mul_f32 v8, v17, v17
  v_fmac_f32 v8, v18, v18
  v_rcp_f32 v8, v8
  v_mul_f32 v116, v7, v17
  v_fmac_f32 v116, v109, v18
  v_mul_f32 v117, v109, v17
  v_fma_f32 v117, -v7, v18, v117
  v_add_f32 v8, v8, v8
  v_mul_f32 v116, v116, v8
  v_mul_f32 v117, v117, v8
  v_sub_f32 v118, 0, v109
  v_mov_b32 v119, v109
  v_mov_b32 v4, v108
  v_mov_b32 v5, v109
  v_mul_f32 v6, v5, v5
  v_mul_f32 v7, v4, v5
  v_fma_f32 v4, v4, v4, -v6
  v_add_f32 v5, v7, v7
  v_mul_f32 v6, v5, v5
  v_mul_f32 v7, v4, v5
  v_fma_f32 v4, v4, v4, -v6
  v_add_f32 v5, v7, v7
  v_mul_f32 v6, v5, v5
  v_mul_f32 v7, v4, v5
  v_fma_f32 v4, v4, v4, -v6
  v_add_f32 v5, v7, v7
  v_mov_b32 v110, v4
  v_mov_b32 v111, v5
  v_mul_f32 v6, v5, v5
  v_mul_f32 v7, v4, v5
  v_fma_f32 v4, v4, v4, -v6
  v_add_f32 v5, v7, v7
  v_mul_f32 v6, v5, v5
  v_mul_f32 v7, v4, v5
  v_fma_f32 v4, v4, v4, -v6
  v_add_f32 v5, v7, v7
  v_mov_b32 v112, v4
  v_mov_b32 v113, v5
  v_mul_f32 v6, v5, v5
  v_mul_f32 v7, v4, v5
  v_fma_f32 v4, v4, v4, -v6
  v_add_f32 v5, v7, v7
  v_mul_f32 v6, v5, v5
  v_mul_f32 v7, v4, v5
  v_fma_f32 v4, v4, v4, -v6
  v_add_f32 v5, v7, v7
  v_mul_f32 v6, v5, v5
  v_mul_f32 v7, v4, v5
  v_fma_f32 v4, v4, v4, -v6
  v_add_f32 v5, v7, v7
  v_mov_b32 v114, v4
  v_mov_b32 v115, v5
  s_waitcnt vmcnt(0)
  s_lshl_b32 s74, s6, 5
  v_min_u32 v240, 31, v1
  v_add_u32 v240, s74, v240
  v_lshlrev_b32 v240, 6, v240
  s_cmp_eq_u32 s3, 0
  s_mov_b32 s51, 2147483648
  s_cselect_b32 s50, 13664256, s51
  v_add_u32 v240, s50, v240
  buffer_load_dword v244, v240, s[52:55], 0 offen sc1
  s_waitcnt vmcnt(0)
  s_cmp_lg_u32 s3, 0
  s_cbranch_scc1 L_pco14
  s_mov_b32 s50, 0
L_pc13:
  v_xor_b32 v244, s75, v244
  v_cmp_ne_u32 vcc, 0, v244
  s_add_u32 s50, s50, 1
  s_cmp_ge_u32 s50, 131072
  s_cbranch_scc1 L_pco14
  s_cbranch_vccz L_pco14
  s_sleep 4
  buffer_load_dword v244, v240, s[52:55], 0 offen sc1
  s_waitcnt vmcnt(0)
  s_branch L_pc13
L_pco14:
  s_barrier
  s_add_u32 s14, s7, 0
  s_cmp_ge_u32 s14, 7
  s_cselect_b32 s51, 7, 0
  s_sub_u32 s14, s14, s51
  s_lshl_b32 s14, s14, 12
  s_add_u32 s14, s14, s101
  buffer_load_dwordx4 v[64:67], v24, s[52:55], s14 offen offset:0 sc1
  buffer_load_dwordx4 v[68:71], v24, s[52:55], s14 offen offset:1024 sc1
  buffer_load_dwordx4 v[72:75], v24, s[52:55], s14 offen offset:2048 sc1
  buffer_load_dwordx4 v[76:79], v24, s[52:55], s14 offen offset:3072 sc1
  ds_read_b128 v[32:35], v26 offset:0
  ds_read_b128 v[36:39], v26 offset:4096
  ds_read_b128 v[40:43], v26 offset:8192
  ds_read_b128 v[44:47], v26 offset:12288
  s_waitcnt vmcnt(3) lgkmcnt(0)
  ds_read_b128 v[48:51], v27 offset:0
  ds_read_b128 v[52:55], v27 offset:4096
  ds_read_b128 v[56:59], v27 offset:8192
  ds_read_b128 v[60:63], v27 offset:12288
  v_mfma_f32_32x32x16_bf16 v[128:143], v[64:67], v[32:35], 0
  v_mfma_f32_32x32x16_bf16 v[144:159], v[64:67], v[36:39], 0
  s_add_u32 s14, s7, 1
  s_cmp_ge_u32 s14, 7
  s_cselect_b32 s51, 7, 0
  s_sub_u32 s14, s14, s51
  s_lshl_b32 s14, s14, 12
  s_add_u32 s14, s14, s101
  buffer_load_dwordx4 v[80:83], v24, s[52:55], s14 offen offset:0 sc1
  v_mfma_f32_32x32x16_bf16 v[160:175], v[64:67], v[40:43], 0
  v_mfma_f32_32x32x16_bf16 v[176:191], v[64:67], v[44:47], 0
  s_waitcnt vmcnt(3) lgkmcnt(0)
  ds_read_b128 v[32:35], v28 offset:0
  ds_read_b128 v[36:39], v28 offset:4096
  ds_read_b128 v[40:43], v28 offset:8192
  ds_read_b128 v[44:47], v28 offset:12288
  v_mfma_f32_32x32x16_bf16 v[128:143], v[68:71], v[48:51], v[128:143]
  v_mfma_f32_32x32x16_bf16 v[144:159], v[68:71], v[52:55], v[144:159]
  buffer_load_dwordx4 v[84:87], v24, s[52:55], s14 offen offset:1024 sc1
  v_mfma_f32_32x32x16_bf16 v[160:175], v[68:71], v[56:59], v[160:175]
  v_mfma_f32_32x32x16_bf16 v[176:191], v[68:71], v[60:63], v[176:191]
  s_waitcnt vmcnt(3) lgkmcnt(0)
  ds_read_b128 v[48:51], v29 offset:0
  ds_read_b128 v[52:55], v29 offset:4096
  ds_read_b128 v[56:59], v29 offset:8192
  ds_read_b128 v[60:63], v29 offset:12288
  v_mfma_f32_32x32x16_bf16 v[128:143], v[72:75], v[32:35], v[128:143]
  v_mfma_f32_32x32x16_bf16 v[144:159], v[72:75], v[36:39], v[144:159]
  buffer_load_dwordx4 v[88:91], v24, s[52:55], s14 offen offset:2048 sc1
  v_mfma_f32_32x32x16_bf16 v[160:175], v[72:75], v[40:43], v[160:175]
  v_mfma_f32_32x32x16_bf16 v[176:191], v[72:75], v[44:47], v[176:191]
  s_waitcnt vmcnt(3) lgkmcnt(0)
  s_add_u32 s15, s7, 1
  s_cmp_ge_u32 s15, 7
  s_cselect_b32 s51, 7, 0
  s_sub_u32 s15, s15, s51
  s_cmp_eq_u32 s15, 0
  s_mov_b32 s51, 4294868992
  s_cselect_b32 s15, s51, 16384
  v_add_u32 v26, s15, v26
  v_add_u32 v27, s15, v27
  v_add_u32 v28, s15, v28
  v_add_u32 v29, s15, v29
  ds_read_b128 v[32:35], v26 offset:0
  ds_read_b128 v[36:39], v26 offset:4096
  ds_read_b128 v[40:43], v26 offset:8192
  ds_read_b128 v[44:47], v26 offset:12288
  v_mfma_f32_32x32x16_bf16 v[128:143], v[76:79], v[48:51], v[128:143]
  v_mfma_f32_32x32x16_bf16 v[144:159], v[76:79], v[52:55], v[144:159]
  buffer_load_dwordx4 v[92:95], v24, s[52:55], s14 offen offset:3072 sc1
  v_mfma_f32_32x32x16_bf16 v[160:175], v[76:79], v[56:59], v[160:175]
  v_mfma_f32_32x32x16_bf16 v[176:191], v[76:79], v[60:63], v[176:191]
  s_waitcnt vmcnt(3) lgkmcnt(0)
  ds_read_b128 v[48:51], v27 offset:0
  ds_read_b128 v[52:55], v27 offset:4096
  ds_read_b128 v[56:59], v27 offset:8192
  ds_read_b128 v[60:63], v27 offset:12288
  v_mfma_f32_32x32x16_bf16 v[128:143], v[80:83], v[32:35], v[128:143]
  v_mfma_f32_32x32x16_bf16 v[144:159], v[80:83], v[36:39], v[144:159]
  s_add_u32 s14, s7, 2
  s_cmp_ge_u32 s14, 7
  s_cselect_b32 s51, 7, 0
  s_sub_u32 s14, s14, s51
  s_lshl_b32 s14, s14, 12
  s_add_u32 s14, s14, s101
  buffer_load_dwordx4 v[64:67], v24, s[52:55], s14 offen offset:0 sc1
  v_mfma_f32_32x32x16_bf16 v[160:175], v[80:83], v[40:43], v[160:175]
  v_mfma_f32_32x32x16_bf16 v[176:191], v[80:83], v[44:47], v[176:191]
  s_waitcnt vmcnt(3) lgkmcnt(0)
  ds_read_b128 v[32:35], v28 offset:0
  ds_read_b128 v[36:39], v28 offset:4096
  ds_read_b128 v[40:43], v28 offset:8192
  ds_read_b128 v[44:47], v28 offset:12288
  v_mfma_f32_32x32x16_bf16 v[128:143], v[84:87], v[48:51], v[128:143]
  v_mfma_f32_32x32x16_bf16 v[144:159], v[84:87], v[52:55], v[144:159]
  buffer_load_dwordx4 v[68:71], v24, s[52:55], s14 offen offset:1024 sc1
  v_mfma_f32_32x32x16_bf16 v[160:175], v[84:87], v[56:59], v[160:175]
  v_mfma_f32_32x32x16_bf16 v[176:191], v[84:87], v[60:63], v[176:191]
  s_waitcnt vmcnt(3) lgkmcnt(0)
  ds_read_b128 v[48:51], v29 offset:0
  ds_read_b128 v[52:55], v29 offset:4096
  ds_read_b128 v[56:59], v29 offset:8192
  ds_read_b128 v[60:63], v29 offset:12288
  v_mfma_f32_32x32x16_bf16 v[128:143], v[88:91], v[32:35], v[128:143]
  v_mfma_f32_32x32x16_bf16 v[144:159], v[88:91], v[36:39], v[144:159]
  buffer_load_dwordx4 v[72:75], v24, s[52:55], s14 offen offset:2048 sc1
  v_mfma_f32_32x32x16_bf16 v[160:175], v[88:91], v[40:43], v[160:175]
  v_mfma_f32_32x32x16_bf16 v[176:191], v[88:91], v[44:47], v[176:191]
  s_waitcnt vmcnt(3) lgkmcnt(0)
  s_add_u32 s15, s7, 2
  s_cmp_ge_u32 s15, 7
  s_cselect_b32 s51, 7, 0
  s_sub_u32 s15, s15, s51
  s_cmp_eq_u32 s15, 0
  s_mov_b32 s51, 4294868992
  s_cselect_b32 s15, s51, 16384
  v_add_u32 v26, s15, v26
  v_add_u32 v27, s15, v27
  v_add_u32 v28, s15, v28
  v_add_u32 v29, s15, v29
  ds_read_b128 v[32:35], v26 offset:0
  ds_read_b128 v[36:39], v26 offset:4096
  ds_read_b128 v[40:43], v26 offset:8192
  ds_read_b128 v[44:47], v26 offset:12288
  v_mfma_f32_32x32x16_bf16 v[128:143], v[92:95], v[48:51], v[128:143]
  v_mfma_f32_32x32x16_bf16 v[144:159], v[92:95], v[52:55], v[144:159]
  buffer_load_dwordx4 v[76:79], v24, s[52:55], s14 offen offset:3072 sc1
  v_mfma_f32_32x32x16_bf16 v[160:175], v[92:95], v[56:59], v[160:175]
  v_mfma_f32_32x32x16_bf16 v[176:191], v[92:95], v[60:63], v[176:191]
  s_waitcnt vmcnt(3) lgkmcnt(0)
  ds_read_b128 v[48:51], v27 offset:0
  ds_read_b128 v[52:55], v27 offset:4096
  ds_read_b128 v[56:59], v27 offset:8192
  ds_read_b128 v[60:63], v27 offset:12288
  v_mfma_f32_32x32x16_bf16 v[128:143], v[64:67], v[32:35], v[128:143]
  v_mfma_f32_32x32x16_bf16 v[144:159], v[64:67], v[36:39], v[144:159]
  s_add_u32 s14, s7, 3
  s_cmp_ge_u32 s14, 7
  s_cselect_b32 s51, 7, 0
  s_sub_u32 s14, s14, s51
  s_lshl_b32 s14, s14, 12
  s_add_u32 s14, s14, s101
  buffer_load_dwordx4 v[80:83], v24, s[52:55], s14 offen offset:0 sc1
  v_mfma_f32_32x32x16_bf16 v[160:175], v[64:67], v[40:43], v[160:175]
  v_mfma_f32_32x32x16_bf16 v[176:191], v[64:67], v[44:47], v[176:191]
  s_waitcnt vmcnt(3) lgkmcnt(0)
  ds_read_b128 v[32:35], v28 offset:0
  ds_read_b128 v[36:39], v28 offset:4096
  ds_read_b128 v[40:43], v28 offset:8192
  ds_read_b128 v[44:47], v28 offset:12288
  v_mfma_f32_32x32x16_bf16 v[128:143], v[68:71], v[48:51], v[128:143]
  v_mfma_f32_32x32x16_bf16 v[144:159], v[68:71], v[52:55], v[144:159]
  buffer_load_dwordx4 v[84:87], v24, s[52:55], s14 offen offset:1024 sc1
  v_mfma_f32_32x32x16_bf16 v[160:175], v[68:71], v[56:59], v[160:175]
  v_mfma_f32_32x32x16_bf16 v[176:191], v[68:71], v[60:63], v[176:191]
  s_waitcnt vmcnt(3) lgkmcnt(0)
  ds_read_b128 v[48:51], v29 offset:0
  ds_read_b128 v[52:55], v29 offset:4096
  ds_read_b128 v[56:59], v29 offset:8192
  ds_read_b128 v[60:63], v29 offset:12288
  v_mfma_f32_32x32x16_bf16 v[128:143], v[72:75], v[32:35], v[128:143]
  v_mfma_f32_32x32x16_bf16 v[144:159], v[72:75], v[36:39], v[144:159]
  buffer_load_dwordx4 v[88:91], v24, s[52:55], s14 offen offset:2048 sc1
  v_mfma_f32_32x32x16_bf16 v[160:175], v[72:75], v[40:43], v[160:175]
  v_mfma_f32_32x32x16_bf16 v[176:191], v[72:75], v[44:47], v[176:191]
  s_waitcnt vmcnt(3) lgkmcnt(0)
  s_add_u32 s15, s7, 3
  s_cmp_ge_u32 s15, 7
  s_cselect_b32 s51, 7, 0
  s_sub_u32 s15, s15, s51
  s_cmp_eq_u32 s15, 0
  s_mov_b32 s51, 4294868992
  s_cselect_b32 s15, s51, 16384
  v_add_u32 v26, s15, v26
  v_add_u32 v27, s15, v27
  v_add_u32 v28, s15, v28
  v_add_u32 v29, s15, v29
  ds_read_b128 v[32:35], v26 offset:0
  ds_read_b128 v[36:39], v26 offset:4096
  ds_read_b128 v[40:43], v26 offset:8192
  ds_read_b128 v[44:47], v26 offset:12288
  v_mfma_f32_32x32x16_bf16 v[128:143], v[76:79], v[48:51], v[128:143]
  v_mfma_f32_32x32x16_bf16 v[144:159], v[76:79], v[52:55], v[144:159]
  buffer_load_dwordx4 v[92:95], v24, s[52:55], s14 offen offset:3072 sc1
  v_mfma_f32_32x32x16_bf16 v[160:175], v[76:79], v[56:59], v[160:175]
  v_mfma_f32_32x32x16_bf16 v[176:191], v[76:79], v[60:63], v[176:191]
  s_waitcnt vmcnt(3) lgkmcnt(0)
  ds_read_b128 v[48:51], v27 offset:0
  ds_read_b128 v[52:55], v27 offset:4096
  ds_read_b128 v[56:59], v27 offset:8192
  ds_read_b128 v[60:63], v27 offset:12288
  v_mfma_f32_32x32x16_bf16 v[128:143], v[80:83], v[32:35], v[128:143]
  v_mfma_f32_32x32x16_bf16 v[144:159], v[80:83], v[36:39], v[144:159]
  s_add_u32 s14, s7, 4
  s_cmp_ge_u32 s14, 7
  s_cselect_b32 s51, 7, 0
  s_sub_u32 s14, s14, s51
  s_lshl_b32 s14, s14, 12
  s_add_u32 s14, s14, s101
  buffer_load_dwordx4 v[64:67], v24, s[52:55], s14 offen offset:0 sc1
  v_mfma_f32_32x32x16_bf16 v[160:175], v[80:83], v[40:43], v[160:175]
  v_mfma_f32_32x32x16_bf16 v[176:191], v[80:83], v[44:47], v[176:191]
  s_waitcnt vmcnt(3) lgkmcnt(0)
  ds_read_b128 v[32:35], v28 offset:0
  ds_read_b128 v[36:39], v28 offset:4096
  ds_read_b128 v[40:43], v28 offset:8192
  ds_read_b128 v[44:47], v28 offset:12288
  v_mfma_f32_32x32x16_bf16 v[128:143], v[84:87], v[48:51], v[128:143]
  v_mfma_f32_32x32x16_bf16 v[144:159], v[84:87], v[52:55], v[144:159]
  buffer_load_dwordx4 v[68:71], v24, s[52:55], s14 offen offset:1024 sc1
  v_mfma_f32_32x32x16_bf16 v[160:175], v[84:87], v[56:59], v[160:175]
  v_mfma_f32_32x32x16_bf16 v[176:191], v[84:87], v[60:63], v[176:191]
  s_waitcnt vmcnt(3) lgkmcnt(0)
  ds_read_b128 v[48:51], v29 offset:0
  ds_read_b128 v[52:55], v29 offset:4096
  ds_read_b128 v[56:59], v29 offset:8192
  ds_read_b128 v[60:63], v29 offset:12288
  v_mfma_f32_32x32x16_bf16 v[128:143], v[88:91], v[32:35], v[128:143]
  v_mfma_f32_32x32x16_bf16 v[144:159], v[88:91], v[36:39], v[144:159]
  buffer_load_dwordx4 v[72:75], v24, s[52:55], s14 offen offset:2048 sc1
  v_mfma_f32_32x32x16_bf16 v[160:175], v[88:91], v[40:43], v[160:175]
  v_mfma_f32_32x32x16_bf16 v[176:191], v[88:91], v[44:47], v[176:191]
  s_waitcnt vmcnt(3) lgkmcnt(0)
  s_add_u32 s15, s7, 4
  s_cmp_ge_u32 s15, 7
  s_cselect_b32 s51, 7, 0
  s_sub_u32 s15, s15, s51
  s_cmp_eq_u32 s15, 0
  s_mov_b32 s51, 4294868992
  s_cselect_b32 s15, s51, 16384
  v_add_u32 v26, s15, v26
  v_add_u32 v27, s15, v27
  v_add_u32 v28, s15, v28
  v_add_u32 v29, s15, v29
  ds_read_b128 v[32:35], v26 offset:0
  ds_read_b128 v[36:39], v26 offset:4096
  ds_read_b128 v[40:43], v26 offset:8192
  ds_read_b128 v[44:47], v26 offset:12288
  v_mfma_f32_32x32x16_bf16 v[128:143], v[92:95], v[48:51], v[128:143]
  v_mfma_f32_32x32x16_bf16 v[144:159], v[92:95], v[52:55], v[144:159]
  buffer_load_dwordx4 v[76:79], v24, s[52:55], s14 offen offset:3072 sc1
  v_mfma_f32_32x32x16_bf16 v[160:175], v[92:95], v[56:59], v[160:175]
  v_mfma_f32_32x32x16_bf16 v[176:191], v[92:95], v[60:63], v[176:191]
  s_waitcnt vmcnt(3) lgkmcnt(0)
  ds_read_b128 v[48:51], v27 offset:0
  ds_read_b128 v[52:55], v27 offset:4096
  ds_read_b128 v[56:59], v27 offset:8192
  ds_read_b128 v[60:63], v27 offset:12288
  v_mfma_f32_32x32x16_bf16 v[128:143], v[64:67], v[32:35], v[128:143]
  v_mfma_f32_32x32x16_bf16 v[144:159], v[64:67], v[36:39], v[144:159]
  s_add_u32 s14, s7, 5
  s_cmp_ge_u32 s14, 7
  s_cselect_b32 s51, 7, 0
  s_sub_u32 s14, s14, s51
  s_lshl_b32 s14, s14, 12
  s_add_u32 s14, s14, s101
  buffer_load_dwordx4 v[80:83], v24, s[52:55], s14 offen offset:0 sc1
  v_mfma_f32_32x32x16_bf16 v[160:175], v[64:67], v[40:43], v[160:175]
  v_mfma_f32_32x32x16_bf16 v[176:191], v[64:67], v[44:47], v[176:191]
  s_waitcnt vmcnt(3) lgkmcnt(0)
  ds_read_b128 v[32:35], v28 offset:0
  ds_read_b128 v[36:39], v28 offset:4096
  ds_read_b128 v[40:43], v28 offset:8192
  ds_read_b128 v[44:47], v28 offset:12288
  v_mfma_f32_32x32x16_bf16 v[128:143], v[68:71], v[48:51], v[128:143]
  v_mfma_f32_32x32x16_bf16 v[144:159], v[68:71], v[52:55], v[144:159]
  buffer_load_dwordx4 v[84:87], v24, s[52:55], s14 offen offset:1024 sc1
  v_mfma_f32_32x32x16_bf16 v[160:175], v[68:71], v[56:59], v[160:175]
  v_mfma_f32_32x32x16_bf16 v[176:191], v[68:71], v[60:63], v[176:191]
  s_waitcnt vmcnt(3) lgkmcnt(0)
  ds_read_b128 v[48:51], v29 offset:0
  ds_read_b128 v[52:55], v29 offset:4096
  ds_read_b128 v[56:59], v29 offset:8192
  ds_read_b128 v[60:63], v29 offset:12288
  v_mfma_f32_32x32x16_bf16 v[128:143], v[72:75], v[32:35], v[128:143]
  v_mfma_f32_32x32x16_bf16 v[144:159], v[72:75], v[36:39], v[144:159]
  buffer_load_dwordx4 v[88:91], v24, s[52:55], s14 offen offset:2048 sc1
  v_mfma_f32_32x32x16_bf16 v[160:175], v[72:75], v[40:43], v[160:175]
  v_mfma_f32_32x32x16_bf16 v[176:191], v[72:75], v[44:47], v[176:191]
  s_waitcnt vmcnt(3) lgkmcnt(0)
  s_add_u32 s15, s7, 5
  s_cmp_ge_u32 s15, 7
  s_cselect_b32 s51, 7, 0
  s_sub_u32 s15, s15, s51
  s_cmp_eq_u32 s15, 0
  s_mov_b32 s51, 4294868992
  s_cselect_b32 s15, s51, 16384
  v_add_u32 v26, s15, v26
  v_add_u32 v27, s15, v27
  v_add_u32 v28, s15, v28
  v_add_u32 v29, s15, v29
  ds_read_b128 v[32:35], v26 offset:0
  ds_read_b128 v[36:39], v26 offset:4096
  ds_read_b128 v[40:43], v26 offset:8192
  ds_read_b128 v[44:47], v26 offset:12288
  v_mfma_f32_32x32x16_bf16 v[128:143], v[76:79], v[48:51], v[128:143]
  v_mfma_f32_32x32x16_bf16 v[144:159], v[76:79], v[52:55], v[144:159]
  buffer_load_dwordx4 v[92:95], v24, s[52:55], s14 offen offset:3072 sc1
  v_mfma_f32_32x32x16_bf16 v[160:175], v[76:79], v[56:59], v[160:175]
  v_mfma_f32_32x32x16_bf16 v[176:191], v[76:79], v[60:63], v[176:191]
  s_waitcnt vmcnt(3) lgkmcnt(0)
  ds_read_b128 v[48:51], v27 offset:0
  ds_read_b128 v[52:55], v27 offset:4096
  ds_read_b128 v[56:59], v27 offset:8192
  ds_read_b128 v[60:63], v27 offset:12288
  v_mfma_f32_32x32x16_bf16 v[128:143], v[80:83], v[32:35], v[128:143]
  v_mfma_f32_32x32x16_bf16 v[144:159], v[80:83], v[36:39], v[144:159]
  s_add_u32 s14, s7, 6
  s_cmp_ge_u32 s14, 7
  s_cselect_b32 s51, 7, 0
  s_sub_u32 s14, s14, s51
  s_lshl_b32 s14, s14, 12
  s_add_u32 s14, s14, s101
  buffer_load_dwordx4 v[64:67], v24, s[52:55], s14 offen offset:0 sc1
  v_mfma_f32_32x32x16_bf16 v[160:175], v[80:83], v[40:43], v[160:175]
  v_mfma_f32_32x32x16_bf16 v[176:191], v[80:83], v[44:47], v[176:191]
  s_waitcnt vmcnt(3) lgkmcnt(0)
  ds_read_b128 v[32:35], v28 offset:0
  ds_read_b128 v[36:39], v28 offset:4096
  ds_read_b128 v[40:43], v28 offset:8192
  ds_read_b128 v[44:47], v28 offset:12288
  v_mfma_f32_32x32x16_bf16 v[128:143], v[84:87], v[48:51], v[128:143]
  v_mfma_f32_32x32x16_bf16 v[144:159], v[84:87], v[52:55], v[144:159]
  buffer_load_dwordx4 v[68:71], v24, s[52:55], s14 offen offset:1024 sc1
  v_mfma_f32_32x32x16_bf16 v[160:175], v[84:87], v[56:59], v[160:175]
  v_mfma_f32_32x32x16_bf16 v[176:191], v[84:87], v[60:63], v[176:191]
  s_waitcnt vmcnt(3) lgkmcnt(0)
  ds_read_b128 v[48:51], v29 offset:0
  ds_read_b128 v[52:55], v29 offset:4096
  ds_read_b128 v[56:59], v29 offset:8192
  ds_read_b128 v[60:63], v29 offset:12288
  v_mfma_f32_32x32x16_bf16 v[128:143], v[88:91], v[32:35], v[128:143]
  v_mfma_f32_32x32x16_bf16 v[144:159], v[88:91], v[36:39], v[144:159]
  buffer_load_dwordx4 v[72:75], v24, s[52:55], s14 offen offset:2048 sc1
  v_mfma_f32_32x32x16_bf16 v[160:175], v[88:91], v[40:43], v[160:175]
  v_mfma_f32_32x32x16_bf16 v[176:191], v[88:91], v[44:47], v[176:191]
  s_waitcnt vmcnt(3) lgkmcnt(0)
  s_add_u32 s15, s7, 6
  s_cmp_ge_u32 s15, 7
  s_cselect_b32 s51, 7, 0
  s_sub_u32 s15, s15, s51
  s_cmp_eq_u32 s15, 0
  s_mov_b32 s51, 4294868992
  s_cselect_b32 s15, s51, 16384
  v_add_u32 v26, s15, v26
  v_add_u32 v27, s15, v27
  v_add_u32 v28, s15, v28
  v_add_u32 v29, s15, v29
  ds_read_b128 v[32:35], v26 offset:0
  ds_read_b128 v[36:39], v26 offset:4096
  ds_read_b128 v[40:43], v26 offset:8192
  ds_read_b128 v[44:47], v26 offset:12288
  v_mfma_f32_32x32x16_bf16 v[128:143], v[92:95], v[48:51], v[128:143]
  v_mfma_f32_32x32x16_bf16 v[144:159], v[92:95], v[52:55], v[144:159]
  buffer_load_dwordx4 v[76:79], v24, s[52:55], s14 offen offset:3072 sc1
  v_mfma_f32_32x32x16_bf16 v[160:175], v[92:95], v[56:59], v[160:175]
  v_mfma_f32_32x32x16_bf16 v[176:191], v[92:95], v[60:63], v[176:191]
  s_waitcnt vmcnt(3) lgkmcnt(0)
  ds_read_b128 v[48:51], v27 offset:0
  ds_read_b128 v[52:55], v27 offset:4096
  ds_read_b128 v[56:59], v27 offset:8192
  ds_read_b128 v[60:63], v27 offset:12288
  v_mfma_f32_32x32x16_bf16 v[128:143], v[64:67], v[32:35], v[128:143]
  v_mfma_f32_32x32x16_bf16 v[144:159], v[64:67], v[36:39], v[144:159]
  v_mfma_f32_32x32x16_bf16 v[160:175], v[64:67], v[40:43], v[160:175]
  v_mfma_f32_32x32x16_bf16 v[176:191], v[64:67], v[44:47], v[176:191]
  s_waitcnt vmcnt(2) lgkmcnt(0)
  ds_read_b128 v[32:35], v28 offset:0
  ds_read_b128 v[36:39], v28 offset:4096
  ds_read_b128 v[40:43], v28 offset:8192
  ds_read_b128 v[44:47], v28 offset:12288
  v_mfma_f32_32x32x16_bf16 v[128:143], v[68:71], v[48:51], v[128:143]
  v_mfma_f32_32x32x16_bf16 v[144:159], v[68:71], v[52:55], v[144:159]
  v_mfma_f32_32x32x16_bf16 v[160:175], v[68:71], v[56:59], v[160:175]
  v_mfma_f32_32x32x16_bf16 v[176:191], v[68:71], v[60:63], v[176:191]
  s_waitcnt vmcnt(1) lgkmcnt(0)
  ds_read_b128 v[48:51], v29 offset:0
  ds_read_b128 v[52:55], v29 offset:4096
  ds_read_b128 v[56:59], v29 offset:8192
  ds_read_b128 v[60:63], v29 offset:12288
  v_mfma_f32_32x32x16_bf16 v[128:143], v[72:75], v[32:35], v[128:143]
  v_mfma_f32_32x32x16_bf16 v[144:159], v[72:75], v[36:39], v[144:159]
  v_mfma_f32_32x32x16_bf16 v[160:175], v[72:75], v[40:43], v[160:175]
  v_mfma_f32_32x32x16_bf16 v[176:191], v[72:75], v[44:47], v[176:191]
  s_waitcnt vmcnt(0) lgkmcnt(0)
  v_mfma_f32_32x32x16_bf16 v[128:143], v[76:79], v[48:51], v[128:143]
  v_mfma_f32_32x32x16_bf16 v[144:159], v[76:79], v[52:55], v[144:159]
  v_mfma_f32_32x32x16_bf16 v[160:175], v[76:79], v[56:59], v[160:175]
  v_mfma_f32_32x32x16_bf16 v[176:191], v[76:79], v[60:63], v[176:191]
  v_and_b32 v27, 31, v1
  v_lshlrev_b32 v24, 4, v27
  v_lshrrev_b32 v26, 5, v1
  v_mul_u32_u24 v26, 7168, v26
  v_add_u32 v24, v24, v26
  v_lshlrev_b32 v25, 3, v27
  v_add_u32 v25, 147456, v25
  s_lshl_b32 s9, s6, 5
  s_lshl_b32 s50, s3, 2
  s_add_u32 s9, s9, s50
  s_mul_i32 s9, s9, 7168
  s_lshl_b32 s50, s7, 10
  s_add_u32 s9, s9, s50
  s_add_u32 s9, s9, 9748480
  s_nop 7
  v_mul_f32 v216, v160, v105
  v_mul_f32 v218, v128, v105
  v_mul_f32 v217, v161, v105
  v_mul_f32 v219, v129, v105
  v_fma_f32 v128, v128, v104, -v216
  v_fma_f32 v160, v160, v104, v218
  v_fma_f32 v129, v129, v104, -v217
  v_fma_f32 v161, v161, v104, v219
  v_fma_f32 v192, v96, v128, v129
  v_fma_f32 v193, v96, v160, v161
  v_fma_f32 v192, -v97, v160, v192
  v_fma_f32 v193, v97, v128, v193
  v_mul_f32 v216, v162, v105
  v_mul_f32 v218, v130, v105
  v_mul_f32 v217, v163, v105
  v_mul_f32 v219, v131, v105
  v_fma_f32 v130, v130, v104, -v216
  v_fma_f32 v162, v162, v104, v218
  v_fma_f32 v131, v131, v104, -v217
  v_fma_f32 v163, v163, v104, v219
  v_fma_f32 v194, v96, v192, v130
  v_fma_f32 v195, v96, v193, v162
  v_fma_f32 v194, -v97, v193, v194
  v_fma_f32 v195, v97, v192, v195
  v_fma_f32 v192, v96, v194, v131
  v_fma_f32 v193, v96, v195, v163
  v_fma_f32 v192, -v97, v195, v192
  v_fma_f32 v193, v97, v194, v193
  v_mul_f32 v216, v164, v105
  v_mul_f32 v218, v132, v105
  v_mul_f32 v217, v165, v105
  v_mul_f32 v219, v133, v105
  v_fma_f32 v132, v132, v104, -v216
  v_fma_f32 v164, v164, v104, v218
  v_fma_f32 v133, v133, v104, -v217
  v_fma_f32 v165, v165, v104, v219
  v_fma_f32 v194, v96, v192, v132
  v_fma_f32 v195, v96, v193, v164
  v_fma_f32 v194, -v97, v193, v194
  v_fma_f32 v195, v97, v192, v195
  v_fma_f32 v192, v96, v194, v133
  v_fma_f32 v193, v96, v195, v165
  v_fma_f32 v192, -v97, v195, v192
  v_fma_f32 v193, v97, v194, v193
  v_mul_f32 v216, v166, v105
  v_mul_f32 v218, v134, v105
  v_mul_f32 v217, v167, v105
  v_mul_f32 v219, v135, v105
  v_fma_f32 v134, v134, v104, -v216
  v_fma_f32 v166, v166, v104, v218
  v_fma_f32 v135, v135, v104, -v217
  v_fma_f32 v167, v167, v104, v219
  v_fma_f32 v194, v96, v192, v134
  v_fma_f32 v195, v96, v193, v166
  v_fma_f32 v194, -v97, v193, v194
  v_fma_f32 v195, v97, v192, v195
  v_fma_f32 v212, v96, v194, v135
  v_fma_f32 v213, v96, v195, v167
  v_fma_f32 v212, -v97, v195, v212
  v_fma_f32 v213, v97, v194, v213
  v_mul_f32 v216, v168, v105
  v_mul_f32 v218, v136, v105
  v_mul_f32 v217, v169, v105
  v_mul_f32 v219, v137, v105
  v_fma_f32 v136, v136, v104, -v216
  v_fma_f32 v168, v168, v104, v218
  v_fma_f32 v137, v137, v104, -v217
  v_fma_f32 v169, v169, v104, v219
  v_fma_f32 v192, v96, v136, v137
  v_fma_f32 v193, v96, v168, v169
  v_fma_f32 v192, -v97, v168, v192
  v_fma_f32 v193, v97, v136, v193
  v_mul_f32 v216, v170, v105
  v_mul_f32 v218, v138, v105
  v_mul_f32 v217, v171, v105
  v_mul_f32 v219, v139, v105
  v_fma_f32 v138, v138, v104, -v216
  v_fma_f32 v170, v170, v104, v218
  v_fma_f32 v139, v139, v104, -v217
  v_fma_f32 v171, v171, v104, v219
  v_fma_f32 v194, v96, v192, v138
  v_fma_f32 v195, v96, v193, v170
  v_fma_f32 v194, -v97, v193, v194
  v_fma_f32 v195, v97, v192, v195
  v_fma_f32 v192, v96, v194, v139
  v_fma_f32 v193, v96, v195, v171
  v_fma_f32 v192, -v97, v195, v192
  v_fma_f32 v193, v97, v194, v193
  v_mul_f32 v216, v172, v105
  v_mul_f32 v218, v140, v105
  v_mul_f32 v217, v173, v105
  v_mul_f32 v219, v141, v105
  v_fma_f32 v140, v140, v104, -v216
  v_fma_f32 v172, v172, v104, v218
  v_fma_f32 v141, v141, v104, -v217
  v_fma_f32 v173, v173, v104, v219
  v_fma_f32 v194, v96, v192, v140
  v_fma_f32 v195, v96, v193, v172
  v_fma_f32 v194, -v97, v193, v194
  v_fma_f32 v195, v97, v192, v195
  v_fma_f32 v192, v96, v194, v141
  v_fma_f32 v193, v96, v195, v173
  v_fma_f32 v192, -v97, v195, v192
  v_fma_f32 v193, v97, v194, v193
  v_mul_f32 v216, v174, v105
  v_mul_f32 v218, v142, v105
  v_mul_f32 v217, v175, v105
  v_mul_f32 v219, v143, v105
  v_fma_f32 v142, v142, v104, -v216
  v_fma_f32 v174, v174, v104, v218
  v_fma_f32 v143, v143, v104, -v217
  v_fma_f32 v175, v175, v104, v219
  v_fma_f32 v194, v96, v192, v142
  v_fma_f32 v195, v96, v193, v174
  v_fma_f32 v194, -v97, v193, v194
  v_fma_f32 v195, v97, v192, v195
  v_fma_f32 v214, v96, v194, v143
  v_fma_f32 v215, v96, v195, v175
  v_fma_f32 v214, -v97, v195, v214
  v_fma_f32 v215, v97, v194, v215
  v_mov_b32 v196, v212
  v_mov_b32 v198, v212
  v_mov_b32 v197, v213
  v_mov_b32 v199, v213
  v_mov_b32 v200, v214
  v_mov_b32 v202, v214
  v_mov_b32 v201, v215
  v_mov_b32 v203, v215
  s_nop 1
  v_permlane32_swap_b32 v196, v198
  v_permlane32_swap_b32 v197, v199
  v_permlane32_swap_b32 v200, v202
  v_permlane32_swap_b32 v201, v203
  s_nop 0
  v_fma_f32 v192, v98, v196, v198
  v_fma_f32 v193, v98, v197, v199
  v_fma_f32 v192, -v99, v197, v192
  v_fma_f32 v193, v99, v196, v193
  v_fma_f32 v194, v98, v192, v200
  v_fma_f32 v195, v98, v193, v201
  v_fma_f32 v194, -v99, v193, v194
  v_fma_f32 v195, v99, v192, v195
  v_fma_f32 v192, v98, v194, v202
  v_fma_f32 v193, v98, v195, v203
  v_fma_f32 v192, -v99, v195, v192
  v_fma_f32 v193, v99, v194, v193
  s_lshl_b32 s50, s3, 9
  v_add_u32 v26, s50, v25
  ds_write_b64 v26, v[192:193] offset:0
  v_mul_f32 v216, v176, v117
  v_mul_f32 v218, v144, v117
  v_mul_f32 v217, v177, v117
  v_mul_f32 v219, v145, v117
  v_fma_f32 v144, v144, v116, -v216
  v_fma_f32 v176, v176, v116, v218
  v_fma_f32 v145, v145, v116, -v217
  v_fma_f32 v177, v177, v116, v219
  v_fma_f32 v192, v108, v144, v145
  v_fma_f32 v193, v108, v176, v177
  v_fma_f32 v192, -v109, v176, v192
  v_fma_f32 v193, v109, v144, v193
  v_mul_f32 v216, v178, v117
  v_mul_f32 v218, v146, v117
  v_mul_f32 v217, v179, v117
  v_mul_f32 v219, v147, v117
  v_fma_f32 v146, v146, v116, -v216
  v_fma_f32 v178, v178, v116, v218
  v_fma_f32 v147, v147, v116, -v217
  v_fma_f32 v179, v179, v116, v219
  v_fma_f32 v194, v108, v192, v146
  v_fma_f32 v195, v108, v193, v178
  v_fma_f32 v194, -v109, v193, v194
  v_fma_f32 v195, v109, v192, v195
  v_fma_f32 v192, v108, v194, v147
  v_fma_f32 v193, v108, v195, v179
  v_fma_f32 v192, -v109, v195, v192
  v_fma_f32 v193, v109, v194, v193
  v_mul_f32 v216, v180, v117
  v_mul_f32 v218, v148, v117
  v_mul_f32 v217, v181, v117
  v_mul_f32 v219, v149, v117
  v_fma_f32 v148, v148, v116, -v216
  v_fma_f32 v180, v180, v116, v218
  v_fma_f32 v149, v149, v116, -v217
  v_fma_f32 v181, v181, v116, v219
  v_fma_f32 v194, v108, v192, v148
  v_fma_f32 v195, v108, v193, v180
  v_fma_f32 v194, -v109, v193, v194
  v_fma_f32 v195, v109, v192, v195
  v_fma_f32 v192, v108, v194, v149
  v_fma_f32 v193, v108, v195, v181
  v_fma_f32 v192, -v109, v195, v192
  v_fma_f32 v193, v109, v194, v193
  v_mul_f32 v216, v182, v117
  v_mul_f32 v218, v150, v117
  v_mul_f32 v217, v183, v117
  v_mul_f32 v219, v151, v117
  v_fma_f32 v150, v150, v116, -v216
  v_fma_f32 v182, v182, v116, v218
  v_fma_f32 v151, v151, v116, -v217
  v_fma_f32 v183, v183, v116, v219
  v_fma_f32 v194, v108, v192, v150
  v_fma_f32 v195, v108, v193, v182
  v_fma_f32 v194, -v109, v193, v194
  v_fma_f32 v195, v109, v192, v195
  v_fma_f32 v212, v108, v194, v151
  v_fma_f32 v213, v108, v195, v183
  v_fma_f32 v212, -v109, v195, v212
  v_fma_f32 v213, v109, v194, v213
  v_mul_f32 v216, v184, v117
  v_mul_f32 v218, v152, v117
  v_mul_f32 v217, v185, v117
  v_mul_f32 v219, v153, v117
  v_fma_f32 v152, v152, v116, -v216
  v_fma_f32 v184, v184, v116, v218
  v_fma_f32 v153, v153, v116, -v217
  v_fma_f32 v185, v185, v116, v219
  v_fma_f32 v192, v108, v152, v153
  v_fma_f32 v193, v108, v184, v185
  v_fma_f32 v192, -v109, v184, v192
  v_fma_f32 v193, v109, v152, v193
  v_mul_f32 v216, v186, v117
  v_mul_f32 v218, v154, v117
  v_mul_f32 v217, v187, v117
  v_mul_f32 v219, v155, v117
  v_fma_f32 v154, v154, v116, -v216
  v_fma_f32 v186, v186, v116, v218
  v_fma_f32 v155, v155, v116, -v217
  v_fma_f32 v187, v187, v116, v219
  v_fma_f32 v194, v108, v192, v154
  v_fma_f32 v195, v108, v193, v186
  v_fma_f32 v194, -v109, v193, v194
  v_fma_f32 v195, v109, v192, v195
  v_fma_f32 v192, v108, v194, v155
  v_fma_f32 v193, v108, v195, v187
  v_fma_f32 v192, -v109, v195, v192
  v_fma_f32 v193, v109, v194, v193
  v_mul_f32 v216, v188, v117
  v_mul_f32 v218, v156, v117
  v_mul_f32 v217, v189, v117
  v_mul_f32 v219, v157, v117
  v_fma_f32 v156, v156, v116, -v216
  v_fma_f32 v188, v188, v116, v218
  v_fma_f32 v157, v157, v116, -v217
  v_fma_f32 v189, v189, v116, v219
  v_fma_f32 v194, v108, v192, v156
  v_fma_f32 v195, v108, v193, v188
  v_fma_f32 v194, -v109, v193, v194
  v_fma_f32 v195, v109, v192, v195
  v_fma_f32 v192, v108, v194, v157
  v_fma_f32 v193, v108, v195, v189
  v_fma_f32 v192, -v109, v195, v192
  v_fma_f32 v193, v109, v194, v193
  v_mul_f32 v216, v190, v117
  v_mul_f32 v218, v158, v117
  v_mul_f32 v217, v191, v117
  v_mul_f32 v219, v159, v117
  v_fma_f32 v158, v158, v116, -v216
  v_fma_f32 v190, v190, v116, v218
  v_fma_f32 v159, v159, v116, -v217
  v_fma_f32 v191, v191, v116, v219
  v_fma_f32 v194, v108, v192, v158
  v_fma_f32 v195, v108, v193, v190
  v_fma_f32 v194, -v109, v193, v194
  v_fma_f32 v195, v109, v192, v195
  v_fma_f32 v214, v108, v194, v159
  v_fma_f32 v215, v108, v195, v191
  v_fma_f32 v214, -v109, v195, v214
  v_fma_f32 v215, v109, v194, v215
  v_mov_b32 v204, v212
  v_mov_b32 v206, v212
  v_mov_b32 v205, v213
  v_mov_b32 v207, v213
  v_mov_b32 v208, v214
  v_mov_b32 v210, v214
  v_mov_b32 v209, v215
  v_mov_b32 v211, v215
  s_nop 1
  v_permlane32_swap_b32 v204, v206
  v_permlane32_swap_b32 v205, v207
  v_permlane32_swap_b32 v208, v210
  v_permlane32_swap_b32 v209, v211
  s_nop 0
  v_fma_f32 v192, v110, v204, v206
  v_fma_f32 v193, v110, v205, v207
  v_fma_f32 v192, -v111, v205, v192
  v_fma_f32 v193, v111, v204, v193
  v_fma_f32 v194, v110, v192, v208
  v_fma_f32 v195, v110, v193, v209
  v_fma_f32 v194, -v111, v193, v194
  v_fma_f32 v195, v111, v192, v195
  v_fma_f32 v192, v110, v194, v210
  v_fma_f32 v193, v110, v195, v211
  v_fma_f32 v192, -v111, v195, v192
  v_fma_f32 v193, v111, v194, v193
  s_lshl_b32 s50, s3, 9
  v_add_u32 v26, s50, v25
  ds_write_b64 v26, v[192:193] offset:256
  s_waitcnt lgkmcnt(0)
  s_barrier
  v_lshlrev_b32 v26, 3, v1
  v_add_u32 v26, 147456, v26
  ds_read_b64 v[32:33], v26 offset:0
  ds_read_b64 v[34:35], v26 offset:512
  ds_read_b64 v[36:37], v26 offset:1024
  ds_read_b64 v[38:39], v26 offset:1536
  ds_read_b64 v[40:41], v26 offset:2048
  ds_read_b64 v[42:43], v26 offset:2560
  ds_read_b64 v[44:45], v26 offset:3072
  ds_read_b64 v[46:47], v26 offset:3584
  v_cmp_gt_u32 vcc, 32, v1
  s_nop 1
  v_cndmask_b32 v48, v112, v100, vcc
  v_cndmask_b32 v50, v114, v102, vcc
  v_cndmask_b32 v49, v113, v101, vcc
  v_cndmask_b32 v51, v115, v103, vcc
  s_waitcnt lgkmcnt(0)
  s_cmp_lg_u32 s3, 0
  s_cbranch_scc1 L_nolb15
  v_mov_b32 v52, v32
  v_mov_b32 v53, v33
  v_fma_f32 v54, v48, v52, v34
  v_fma_f32 v55, v48, v53, v35
  v_fma_f32 v54, -v49, v53, v54
  v_fma_f32 v55, v49, v52, v55
  v_fma_f32 v52, v48, v54, v36
  v_fma_f32 v53, v48, v55, v37
  v_fma_f32 v52, -v49, v55, v52
  v_fma_f32 v53, v49, v54, v53
  v_fma_f32 v54, v48, v52, v38
  v_fma_f32 v55, v48, v53, v39
  v_fma_f32 v54, -v49, v53, v54
  v_fma_f32 v55, v49, v52, v55
  v_fma_f32 v52, v48, v54, v40
  v_fma_f32 v53, v48, v55, v41
  v_fma_f32 v52, -v49, v55, v52
  v_fma_f32 v53, v49, v54, v53
  v_fma_f32 v54, v48, v52, v42
  v_fma_f32 v55, v48, v53, v43
  v_fma_f32 v54, -v49, v53, v54
  v_fma_f32 v55, v49, v52, v55
  v_fma_f32 v52, v48, v54, v44
  v_fma_f32 v53, v48, v55, v45
  v_fma_f32 v52, -v49, v55, v52
  v_fma_f32 v53, v49, v54, v53
  v_fma_f32 v54, v48, v52, v46
  v_fma_f32 v55, v48, v53, v47
  v_fma_f32 v54, -v49, v53, v54
  v_fma_f32 v55, v49, v52, v55
  v_mov_b32 v56, v54
  v_mov_b32 v57, s75
  v_mov_b32 v58, v55
  v_mov_b32 v59, s75
  v_lshlrev_b32 v28, 4, v1
  s_lshl_b32 s50, s7, 3
  s_add_u32 s50, s50, s6
  s_lshl_b32 s50, s50, 10
  s_add_u32 s8, s50, 13418496
  buffer_store_dwordx4 v[56:59], v28, s[52:55], s8 offen sc1
  s_mov_b32 s10, 0
L_lbs17:
  s_cmp_ge_u32 s6, 7
  s_cselect_b32 s50, s8, 2147483648
  s_sub_u32 s50, s50, 7168
  buffer_load_dwordx4 v[64:67], v28, s[52:55], s50 offen sc1
  s_cmp_ge_u32 s6, 6
  s_cselect_b32 s50, s8, 2147483648
  s_sub_u32 s50, s50, 6144
  buffer_load_dwordx4 v[68:71], v28, s[52:55], s50 offen sc1
  s_cmp_ge_u32 s6, 5
  s_cselect_b32 s50, s8, 2147483648
  s_sub_u32 s50, s50, 5120
  buffer_load_dwordx4 v[72:75], v28, s[52:55], s50 offen sc1
  s_cmp_ge_u32 s6, 4
  s_cselect_b32 s50, s8, 2147483648
  s_sub_u32 s50, s50, 4096
  buffer_load_dwordx4 v[76:79], v28, s[52:55], s50 offen sc1
  s_cmp_ge_u32 s6, 3
  s_cselect_b32 s50, s8, 2147483648
  s_sub_u32 s50, s50, 3072
  buffer_load_dwordx4 v[80:83], v28, s[52:55], s50 offen sc1
  s_cmp_ge_u32 s6, 2
  s_cselect_b32 s50, s8, 2147483648
  s_sub_u32 s50, s50, 2048
  buffer_load_dwordx4 v[84:87], v28, s[52:55], s50 offen sc1
  s_cmp_ge_u32 s6, 1
  s_cselect_b32 s50, s8, 2147483648
  s_sub_u32 s50, s50, 1024
  buffer_load_dwordx4 v[88:91], v28, s[52:55], s50 offen sc1
  s_waitcnt vmcnt(0)
  v_mov_b32 v29, 0
  s_cmp_ge_u32 s6, 7
  s_cselect_b32 s50, s75, 0
  v_xor_b32 v65, s50, v65
  v_xor_b32 v67, s50, v67
  v_or3_b32 v29, v29, v65, v67
  s_cmp_ge_u32 s6, 6
  s_cselect_b32 s50, s75, 0
  v_xor_b32 v69, s50, v69
  v_xor_b32 v71, s50, v71
  v_or3_b32 v29, v29, v69, v71
  s_cmp_ge_u32 s6, 5
  s_cselect_b32 s50, s75, 0
  v_xor_b32 v73, s50, v73
  v_xor_b32 v75, s50, v75
  v_or3_b32 v29, v29, v73, v75
  s_cmp_ge_u32 s6, 4
  s_cselect_b32 s50, s75, 0
  v_xor_b32 v77, s50, v77
  v_xor_b32 v79, s50, v79
  v_or3_b32 v29, v29, v77, v79
  s_cmp_ge_u32 s6, 3
  s_cselect_b32 s50, s75, 0
  v_xor_b32 v81, s50, v81
  v_xor_b32 v83, s50, v83
  v_or3_b32 v29, v29, v81, v83
  s_cmp_ge_u32 s6, 2
  s_cselect_b32 s50, s75, 0
  v_xor_b32 v85, s50, v85
  v_xor_b32 v87, s50, v87
  v_or3_b32 v29, v29, v85, v87
  s_cmp_ge_u32 s6, 1
  s_cselect_b32 s50, s75, 0
  v_xor_b32 v89, s50, v89
  v_xor_b32 v91, s50, v91
  v_or3_b32 v29, v29, v89, v91
  v_cmp_ne_u32 vcc, 0, v29
  s_add_u32 s10, s10, 1
  s_cmp_ge_u32 s10, 131072
  s_cbranch_scc1 L_lbgo16
  s_cbranch_vccz L_lbgo16
  s_sleep 4
  s_branch L_lbs17
L_lbgo16:
  v_mov_b32 v52, v64
  v_mov_b32 v53, v66
  v_fma_f32 v54, v50, v52, v68
  v_fma_f32 v55, v50, v53, v70
  v_fma_f32 v54, -v51, v53, v54
  v_fma_f32 v55, v51, v52, v55
  v_fma_f32 v52, v50, v54, v72
  v_fma_f32 v53, v50, v55, v74
  v_fma_f32 v52, -v51, v55, v52
  v_fma_f32 v53, v51, v54, v53
  v_fma_f32 v54, v50, v52, v76
  v_fma_f32 v55, v50, v53, v78
  v_fma_f32 v54, -v51, v53, v54
  v_fma_f32 v55, v51, v52, v55
  v_fma_f32 v52, v50, v54, v80
  v_fma_f32 v53, v50, v55, v82
  v_fma_f32 v52, -v51, v55, v52
  v_fma_f32 v53, v51, v54, v53
  v_fma_f32 v54, v50, v52, v84
  v_fma_f32 v55, v50, v53, v86
  v_fma_f32 v54, -v51, v53, v54
  v_fma_f32 v55, v51, v52, v55
  v_fma_f32 v52, v50, v54, v88
  v_fma_f32 v53, v50, v55, v90
  v_fma_f32 v52, -v51, v55, v52
  v_fma_f32 v53, v51, v54, v53
  ds_write_b64 v26, v[52:53] offset:4096
  s_waitcnt lgkmcnt(0)
L_nolb15:
  s_barrier
  ds_read_b64 v[52:53], v26 offset:4096
  s_waitcnt lgkmcnt(0)
  v_fma_f32 v54, v48, v52, v32
  v_fma_f32 v55, v48, v53, v33
  v_fma_f32 v54, -v49, v53, v54
  v_fma_f32 v55, v49, v52, v55
  s_cmp_ge_u32 s3, 1
  s_cselect_b64 s[50:51], -1, 0
  v_cndmask_b32 v52, v52, v54, s[50:51]
  v_cndmask_b32 v53, v53, v55, s[50:51]
  v_fma_f32 v54, v48, v52, v34
  v_fma_f32 v55, v48, v53, v35
  v_fma_f32 v54, -v49, v53, v54
  v_fma_f32 v55, v49, v52, v55
  s_cmp_ge_u32 s3, 2
  s_cselect_b64 s[50:51], -1, 0
  v_cndmask_b32 v52, v52, v54, s[50:51]
  v_cndmask_b32 v53, v53, v55, s[50:51]
  v_fma_f32 v54, v48, v52, v36
  v_fma_f32 v55, v48, v53, v37
  v_fma_f32 v54, -v49, v53, v54
  v_fma_f32 v55, v49, v52, v55
  s_cmp_ge_u32 s3, 3
  s_cselect_b64 s[50:51], -1, 0
  v_cndmask_b32 v52, v52, v54, s[50:51]
  v_cndmask_b32 v53, v53, v55, s[50:51]
  v_fma_f32 v54, v48, v52, v38
  v_fma_f32 v55, v48, v53, v39
  v_fma_f32 v54, -v49, v53, v54
  v_fma_f32 v55, v49, v52, v55
  s_cmp_ge_u32 s3, 4
  s_cselect_b64 s[50:51], -1, 0
  v_cndmask_b32 v52, v52, v54, s[50:51]
  v_cndmask_b32 v53, v53, v55, s[50:51]
  v_fma_f32 v54, v48, v52, v40
  v_fma_f32 v55, v48, v53, v41
  v_fma_f32 v54, -v49, v53, v54
  v_fma_f32 v55, v49, v52, v55
  s_cmp_ge_u32 s3, 5
  s_cselect_b64 s[50:51], -1, 0
  v_cndmask_b32 v52, v52, v54, s[50:51]
  v_cndmask_b32 v53, v53, v55, s[50:51]
  v_fma_f32 v54, v48, v52, v42
  v_fma_f32 v55, v48, v53, v43
  v_fma_f32 v54, -v49, v53, v54
  v_fma_f32 v55, v49, v52, v55
  s_cmp_ge_u32 s3, 6
  s_cselect_b64 s[50:51], -1, 0
  v_cndmask_b32 v52, v52, v54, s[50:51]
  v_cndmask_b32 v53, v53, v55, s[50:51]
  v_fma_f32 v54, v48, v52, v44
  v_fma_f32 v55, v48, v53, v45
  v_fma_f32 v54, -v49, v53, v54
  v_fma_f32 v55, v49, v52, v55
  s_cmp_ge_u32 s3, 7
  s_cselect_b64 s[50:51], -1, 0
  v_cndmask_b32 v52, v52, v54, s[50:51]
  v_cndmask_b32 v53, v53, v55, s[50:51]
  v_mov_b32 v56, v52
  v_mov_b32 v58, v52
  v_mov_b32 v57, v53
  v_mov_b32 v59, v53
  s_nop 1
  v_permlane32_swap_b32 v56, v58
  v_permlane32_swap_b32 v57, v59
  v_cmp_gt_u32 vcc, 32, v1
  s_nop 0
  v_fma_f32 v32, v98, v56, v196
  v_fma_f32 v33, v98, v57, v197
  v_fma_f32 v32, -v99, v57, v32
  v_fma_f32 v33, v99, v56, v33
  v_fma_f32 v34, v98, v32, v198
  v_fma_f32 v35, v98, v33, v199
  v_fma_f32 v34, -v99, v33, v34
  v_fma_f32 v35, v99, v32, v35
  v_fma_f32 v36, v98, v34, v200
  v_fma_f32 v37, v98, v35, v201
  v_fma_f32 v36, -v99, v35, v36
  v_fma_f32 v37, v99, v34, v37
  v_cndmask_b32 v38, v32, v56, vcc
  v_cndmask_b32 v40, v36, v34, vcc
  v_cndmask_b32 v39, v33, v57, vcc
  v_cndmask_b32 v41, v37, v35, vcc
  v_fma_f32 v42, v96, v38, v128
  v_fma_f32 v43, v96, v39, v160
  v_fma_f32 v42, -v97, v39, v42
  v_fma_f32 v43, v97, v38, v43
  v_fma_f32 v46, v96, v40, v136
  v_fma_f32 v47, v96, v41, v168
  v_fma_f32 v46, -v97, v41, v46
  v_fma_f32 v47, v97, v40, v47
  v_fma_f32 v44, v96, v42, v129
  v_fma_f32 v45, v96, v43, v161
  v_fma_f32 v44, -v97, v43, v44
  v_fma_f32 v45, v97, v42, v45
  v_fma_f32 v48, v96, v46, v137
  v_fma_f32 v49, v96, v47, v169
  v_fma_f32 v48, -v97, v47, v48
  v_fma_f32 v49, v97, v46, v49
  v_cvt_pk_bf16_f32 v64, v42, v44
  v_cvt_pk_bf16_f32 v68, -v43, -v45
  v_cvt_pk_bf16_f32 v72, v46, v48
  v_cvt_pk_bf16_f32 v76, -v47, -v49
  v_fma_f32 v42, v96, v44, v130
  v_fma_f32 v43, v96, v45, v162
  v_fma_f32 v42, -v97, v45, v42
  v_fma_f32 v43, v97, v44, v43
  v_fma_f32 v46, v96, v48, v138
  v_fma_f32 v47, v96, v49, v170
  v_fma_f32 v46, -v97, v49, v46
  v_fma_f32 v47, v97, v48, v47
  v_fma_f32 v44, v96, v42, v131
  v_fma_f32 v45, v96, v43, v163
  v_fma_f32 v44, -v97, v43, v44
  v_fma_f32 v45, v97, v42, v45
  v_fma_f32 v48, v96, v46, v139
  v_fma_f32 v49, v96, v47, v171
  v_fma_f32 v48, -v97, v47, v48
  v_fma_f32 v49, v97, v46, v49
  v_cvt_pk_bf16_f32 v65, v42, v44
  v_cvt_pk_bf16_f32 v69, -v43, -v45
  v_cvt_pk_bf16_f32 v73, v46, v48
  v_cvt_pk_bf16_f32 v77, -v47, -v49
  v_fma_f32 v42, v96, v44, v132
  v_fma_f32 v43, v96, v45, v164
  v_fma_f32 v42, -v97, v45, v42
  v_fma_f32 v43, v97, v44, v43
  v_fma_f32 v46, v96, v48, v140
  v_fma_f32 v47, v96, v49, v172
  v_fma_f32 v46, -v97, v49, v46
  v_fma_f32 v47, v97, v48, v47
  v_fma_f32 v44, v96, v42, v133
  v_fma_f32 v45, v96, v43, v165
  v_fma_f32 v44, -v97, v43, v44
  v_fma_f32 v45, v97, v42, v45
  v_fma_f32 v48, v96, v46, v141
  v_fma_f32 v49, v96, v47, v173
  v_fma_f32 v48, -v97, v47, v48
  v_fma_f32 v49, v97, v46, v49
  v_cvt_pk_bf16_f32 v66, v42, v44
  v_cvt_pk_bf16_f32 v70, -v43, -v45
  v_cvt_pk_bf16_f32 v74, v46, v48
  v_cvt_pk_bf16_f32 v78, -v47, -v49
  v_fma_f32 v42, v96, v44, v134
  v_fma_f32 v43, v96, v45, v166
  v_fma_f32 v42, -v97, v45, v42
  v_fma_f32 v43, v97, v44, v43
  v_fma_f32 v46, v96, v48, v142
  v_fma_f32 v47, v96, v49, v174
  v_fma_f32 v46, -v97, v49, v46
  v_fma_f32 v47, v97, v48, v47
  v_fma_f32 v44, v96, v42, v135
  v_fma_f32 v45, v96, v43, v167
  v_fma_f32 v44, -v97, v43, v44
  v_fma_f32 v45, v97, v42, v45
  v_fma_f32 v48, v96, v46, v143
  v_fma_f32 v49, v96, v47, v175
  v_fma_f32 v48, -v97, v47, v48
  v_fma_f32 v49, v97, v46, v49
  v_cvt_pk_bf16_f32 v67, v42, v44
  v_cvt_pk_bf16_f32 v71, -v43, -v45
  v_cvt_pk_bf16_f32 v75, v46, v48
  v_cvt_pk_bf16_f32 v79, -v47, -v49
  s_add_u32 s50, s9, 0
  s_add_u32 s51, s50, 1835008
  buffer_store_dwordx4 v[64:67], v24, s[52:55], s50 offen sc1
  buffer_store_dwordx4 v[68:71], v24, s[52:55], s51 offen sc1
  s_add_u32 s50, s9, 14336
  s_add_u32 s51, s50, 1835008
  buffer_store_dwordx4 v[72:75], v24, s[52:55], s50 offen sc1
  buffer_store_dwordx4 v[76:79], v24, s[52:55], s51 offen sc1
  v_fma_f32 v32, v110, v58, v204
  v_fma_f32 v33, v110, v59, v205
  v_fma_f32 v32, -v111, v59, v32
  v_fma_f32 v33, v111, v58, v33
  v_fma_f32 v34, v110, v32, v206
  v_fma_f32 v35, v110, v33, v207
  v_fma_f32 v34, -v111, v33, v34
  v_fma_f32 v35, v111, v32, v35
  v_fma_f32 v36, v110, v34, v208
  v_fma_f32 v37, v110, v35, v209
  v_fma_f32 v36, -v111, v35, v36
  v_fma_f32 v37, v111, v34, v37
  v_cndmask_b32 v38, v32, v58, vcc
  v_cndmask_b32 v40, v36, v34, vcc
  v_cndmask_b32 v39, v33, v59, vcc
  v_cndmask_b32 v41, v37, v35, vcc
  v_fma_f32 v42, v108, v38, v144
  v_fma_f32 v43, v108, v39, v176
  v_fma_f32 v42, -v109, v39, v42
  v_fma_f32 v43, v109, v38, v43
  v_fma_f32 v46, v108, v40, v152
  v_fma_f32 v47, v108, v41, v184
  v_fma_f32 v46, -v109, v41, v46
  v_fma_f32 v47, v109, v40, v47
  v_fma_f32 v44, v108, v42, v145
  v_fma_f32 v45, v108, v43, v177
  v_fma_f32 v44, -v109, v43, v44
  v_fma_f32 v45, v109, v42, v45
  v_fma_f32 v48, v108, v46, v153
  v_fma_f32 v49, v108, v47, v185
  v_fma_f32 v48, -v109, v47, v48
  v_fma_f32 v49, v109, v46, v49
  v_cvt_pk_bf16_f32 v80, v42, v44
  v_cvt_pk_bf16_f32 v84, -v43, -v45
  v_cvt_pk_bf16_f32 v88, v46, v48
  v_cvt_pk_bf16_f32 v92, -v47, -v49
  v_fma_f32 v42, v108, v44, v146
  v_fma_f32 v43, v108, v45, v178
  v_fma_f32 v42, -v109, v45, v42
  v_fma_f32 v43, v109, v44, v43
  v_fma_f32 v46, v108, v48, v154
  v_fma_f32 v47, v108, v49, v186
  v_fma_f32 v46, -v109, v49, v46
  v_fma_f32 v47, v109, v48, v47
  v_fma_f32 v44, v108, v42, v147
  v_fma_f32 v45, v108, v43, v179
  v_fma_f32 v44, -v109, v43, v44
  v_fma_f32 v45, v109, v42, v45
  v_fma_f32 v48, v108, v46, v155
  v_fma_f32 v49, v108, v47, v187
  v_fma_f32 v48, -v109, v47, v48
  v_fma_f32 v49, v109, v46, v49
  v_cvt_pk_bf16_f32 v81, v42, v44
  v_cvt_pk_bf16_f32 v85, -v43, -v45
  v_cvt_pk_bf16_f32 v89, v46, v48
  v_cvt_pk_bf16_f32 v93, -v47, -v49
  v_fma_f32 v42, v108, v44, v148
  v_fma_f32 v43, v108, v45, v180
  v_fma_f32 v42, -v109, v45, v42
  v_fma_f32 v43, v109, v44, v43
  v_fma_f32 v46, v108, v48, v156
  v_fma_f32 v47, v108, v49, v188
  v_fma_f32 v46, -v109, v49, v46
  v_fma_f32 v47, v109, v48, v47
  v_fma_f32 v44, v108, v42, v149
  v_fma_f32 v45, v108, v43, v181
  v_fma_f32 v44, -v109, v43, v44
  v_fma_f32 v45, v109, v42, v45
  v_fma_f32 v48, v108, v46, v157
  v_fma_f32 v49, v108, v47, v189
  v_fma_f32 v48, -v109, v47, v48
  v_fma_f32 v49, v109, v46, v49
  v_cvt_pk_bf16_f32 v82, v42, v44
  v_cvt_pk_bf16_f32 v86, -v43, -v45
  v_cvt_pk_bf16_f32 v90, v46, v48
  v_cvt_pk_bf16_f32 v94, -v47, -v49
  v_fma_f32 v42, v108, v44, v150
  v_fma_f32 v43, v108, v45, v182
  v_fma_f32 v42, -v109, v45, v42
  v_fma_f32 v43, v109, v44, v43
  v_fma_f32 v46, v108, v48, v158
  v_fma_f32 v47, v108, v49, v190
  v_fma_f32 v46, -v109, v49, v46
  v_fma_f32 v47, v109, v48, v47
  v_fma_f32 v44, v108, v42, v151
  v_fma_f32 v45, v108, v43, v183
  v_fma_f32 v44, -v109, v43, v44
  v_fma_f32 v45, v109, v42, v45
  v_fma_f32 v48, v108, v46, v159
  v_fma_f32 v49, v108, v47, v191
  v_fma_f32 v48, -v109, v47, v48
  v_fma_f32 v49, v109, v46, v49
  v_cvt_pk_bf16_f32 v83, v42, v44
  v_cvt_pk_bf16_f32 v87, -v43, -v45
  v_cvt_pk_bf16_f32 v91, v46, v48
  v_cvt_pk_bf16_f32 v95, -v47, -v49
  s_add_u32 s50, s9, 512
  s_add_u32 s51, s50, 1835008
  buffer_store_dwordx4 v[80:83], v24, s[52:55], s50 offen sc1
  buffer_store_dwordx4 v[84:87], v24, s[52:55], s51 offen sc1
  s_add_u32 s50, s9, 14848
  s_add_u32 s51, s50, 1835008
  buffer_store_dwordx4 v[88:91], v24, s[52:55], s50 offen sc1
  buffer_store_dwordx4 v[92:95], v24, s[52:55], s51 offen sc1
  s_lshl_b32 s35, s6, 4
  s_add_u32 s35, s35, s7
  s_cmp_lt_u32 s5, 31
  s_cselect_b32 s50, 4, 0
  s_cmp_lt_u32 s3, s50
  s_cbranch_scc1 L_g2h
  s_waitcnt vmcnt(0)
  s_barrier
  s_cmp_lg_u32 s3, 0
  s_cbranch_scc1 L_sig18
  s_lshl_b32 s50, s35, 6
  s_add_u32 s50, s50, 13694976
  v_mov_b32 v252, s50
  v_mov_b32 v253, s75
  v_cmp_eq_u32 vcc, 0, v1
  s_and_saveexec_b64 s[50:51], vcc
  s_cbranch_execz L_sg219
  buffer_store_dword v253, v252, s[52:55], 0 offen sc1
L_sg219:
  s_mov_b64 exec, s[50:51]
L_sig18:
  s_branch L_fin
L_g2h:
  s_sub_u32 s50, s5, 25
  s_and_b32 s34, s50, 1
  s_lshr_b32 s50, s50, 1
  s_add_u32 s7, s50, 4
  s_lshl_b32 s6, s4, 2
  s_add_u32 s6, s6, 3
  s_lshl_b32 s74, s7, 5
  v_min_u32 v241, 27, v1
  v_add_u32 v241, s74, v241
  v_lshlrev_b32 v241, 6, v241
  s_cmp_eq_u32 s3, 0
  s_mov_b32 s51, 2147483648
  s_cselect_b32 s50, 13680640, s51
  v_add_u32 v241, s50, v241
  buffer_load_dword v248, v241, s[52:55], 0 offen sc1
  s_lshl_b32 s13, s3, 13
  s_lshr_b32 s14, s3, 1
  s_lshl_b32 s14, s14, 8
  s_lshl_b32 s50, s6, 3
  s_add_u32 s14, s14, s50
  s_mul_i32 s14, s14, 7168
  s_and_b32 s50, s3, 1
  s_mul_i32 s50, s50, 3584
  s_add_u32 s14, s14, s50
  s_add_u32 s14, s14, 9748480
  s_mul_i32 s15, s7, 336
  s_mul_i32 s50, s3, 14
  s_add_u32 s15, s15, s50
  s_add_u32 s15, s15, 112
  s_mul_i32 s50, s34, 168
  s_add_u32 s15, s15, s50
  s_lshl_b32 s15, s15, 10
  s_add_u32 s15, s15, 3670016
  s_mul_i32 s9, s3, 1835008
  s_lshl_b32 s50, s6, 7
  s_add_u32 s9, s9, s50
  s_mov_b32 s8, s9
  s_mul_i32 s11, s7, 336
  s_mul_i32 s50, s3, 28
  s_add_u32 s11, s11, s50
  s_mul_i32 s50, s34, 168
  s_add_u32 s11, s11, s50
  s_lshl_b32 s11, s11, 10
  s_add_u32 s11, s11, 3670016
  s_mov_b32 s10, s11
  v_lshrrev_b32 v2, 3, v1
  v_mul_u32_u24 v2, 4096, v2
  v_lshrrev_b32 v3, 4, v1
  v_and_b32 v3, 1, v3
  v_lshlrev_b32 v4, 2, v3
  v_and_b32 v5, 7, v1
  v_xor_b32 v4, v4, v5
  v_lshl_add_u32 v2, v4, 4, v2
  v_lshrrev_b32 v4, 1, v1
  v_and_b32 v4, 1, v4
  v_and_b32 v16, 1, v1
  v_lshl_add_u32 v4, v3, 1, v4
  s_lshl_b32 s50, s3, 1
  v_xor_b32 v14, s50, v4
  v_lshrrev_b32 v5, 3, v1
  v_and_b32 v5, 1, v5
  v_lshlrev_b32 v5, 2, v5
  v_xor_b32 v4, v14, v5
  v_lshlrev_b32 v6, 4, v4
  v_lshl_add_u32 v6, v16, 3, v6
  v_lshrrev_b32 v15, 2, v1
  v_and_b32 v15, 3, v15
  v_lshrrev_b32 v5, 5, v1
  v_lshl_add_u32 v4, v5, 3, v15
  v_lshl_add_u32 v6, v4, 7, v6
  v_add_u32 v6, s13, v6
  v_xor_b32 v7, 64, v6
  v_add_u32 v3, 31744, v2
  v_lshrrev_b32 v8, 3, v1
  v_mul_u32_u24 v8, 7168, v8
  v_lshrrev_b32 v9, 4, v1
  v_and_b32 v9, 1, v9
  v_lshlrev_b32 v9, 2, v9
  v_and_b32 v10, 7, v1
  v_xor_b32 v9, v9, v10
  v_lshl_add_u32 v8, v9, 4, v8
  v_lshrrev_b32 v10, 1, v14
  v_and_b32 v10, 1, v10
  v_lshlrev_b32 v10, 2, v10
  v_xor_b32 v10, v10, v15
  v_lshlrev_b32 v10, 4, v10
  v_lshl_add_u32 v10, v14, 7, v10
  v_lshl_add_u32 v10, v5, 10, v10
  v_and_b32 v11, 1, v1
  v_lshl_add_u32 v10, v11, 3, v10
  v_add_u32 v10, s13, v10
  v_xor_b32 v11, 64, v10
  v_xor_b32 v12, 512, v10
  v_xor_b32 v13, 512, v11
  v_lshlrev_b32 v4, 4, v1
  v_add_u32 v5, 172032, v4
  s_mov_b32 s56, s40
  s_and_b32 s57, s41, 0xffff
  s_mov_b32 s58, 7340032
  s_mov_b32 s59, 0x20000
  s_mov_b32 s60, s16
  s_and_b32 s61, s17, 0xffff
  s_mov_b32 s62, 1835008
  s_mov_b32 s63, 0x20000
  s_mov_b32 s64, s44
  s_and_b32 s65, s45, 0xffff
  s_mov_b32 s66, 3670016
  s_mov_b32 s67, 0x20000
  s_add_u32 m0, s13, 0
  s_nop 0
  buffer_load_dwordx4 v2, s[56:59], s8 offen  lds
  buffer_load_dwordx4 v3, s[56:59], s8 offen offset:1024  lds
  s_add_u32 s8, s8, 65536
  s_add_u32 m0, s13, 2048
  s_nop 0
  buffer_load_dwordx4 v2, s[56:59], s8 offen  lds
  buffer_load_dwordx4 v3, s[56:59], s8 offen offset:1024  lds
  s_add_u32 s8, s8, 65536
  s_add_u32 m0, s13, 4096
  s_nop 0
  buffer_load_dwordx4 v2, s[56:59], s8 offen  lds
  buffer_load_dwordx4 v3, s[56:59], s8 offen offset:1024  lds
  s_add_u32 s8, s8, 65536
  s_add_u32 m0, s13, 6144
  s_nop 0
  buffer_load_dwordx4 v2, s[56:59], s8 offen  lds
  buffer_load_dwordx4 v3, s[56:59], s8 offen offset:1024  lds
  s_add_u32 s8, s8, 65536
  v_and_b32 v16, 31, v1
  s_and_b32 s50, s3, 1
  s_lshl_b32 s50, s50, 4
  v_xor_b32 v17, s50, v16
  v_lshrrev_b32 v18, 5, v1
  v_lshlrev_b32 v19, 9, v18
  v_lshl_add_u32 v19, v17, 4, v19
  s_lshr_b32 s72, s3, 1
  s_xor_b32 s50, s72, 0
  s_lshl_b32 s51, s6, 1
  s_add_u32 s51, s51, s50
  s_mul_i32 s51, s51, 28
  s_lshl_b32 s50, s7, 2
  s_add_u32 s51, s51, s50
  s_add_u32 s51, s51, s3
  s_lshl_b32 s51, s51, 10
  s_add_u32 s51, s51, 1835008
  buffer_load_dwordx4 v[160:163], v19, s[52:55], s51 offen sc1
  s_xor_b32 s50, s72, 1
  s_lshl_b32 s51, s6, 1
  s_add_u32 s51, s51, s50
  s_mul_i32 s51, s51, 28
  s_lshl_b32 s50, s7, 2
  s_add_u32 s51, s51, s50
  s_add_u32 s51, s51, s3
  s_lshl_b32 s51, s51, 10
  s_add_u32 s51, s51, 1835008
  buffer_load_dwordx4 v[164:167], v19, s[52:55], s51 offen sc1
  v_mul_u32_u24 v20, 896, v17
  v_lshl_add_u32 v20, v18, 4, v20
  s_xor_b32 s50, s72, 0
  s_lshl_b32 s51, s6, 1
  s_add_u32 s51, s51, s50
  s_mul_i32 s51, s51, 28672
  s_lshl_b32 s50, s7, 7
  s_add_u32 s51, s51, s50
  s_lshl_b32 s50, s3, 5
  s_add_u32 s51, s51, s50
  buffer_load_dwordx4 v[168:171], v20, s[60:63], s51 offen
  s_xor_b32 s50, s72, 1
  s_lshl_b32 s51, s6, 1
  s_add_u32 s51, s51, s50
  s_mul_i32 s51, s51, 28672
  s_lshl_b32 s50, s7, 7
  s_add_u32 s51, s51, s50
  s_lshl_b32 s50, s3, 5
  s_add_u32 s51, s51, s50
  buffer_load_dwordx4 v[172:175], v20, s[60:63], s51 offen
  s_lshl_b32 s50, s6, 6
  v_add_u32 v21, s50, v17
  v_lshlrev_b32 v21, 1, v21
  s_xor_b32 s50, s72, 0
  s_lshl_b32 s50, s50, 6
  v_add_u32 v22, s50, v21
  global_load_ushort v176, v22, s[42:43]
  s_xor_b32 s50, s72, 1
  s_lshl_b32 s50, s50, 6
  v_add_u32 v22, s50, v21
  global_load_ushort v177, v22, s[42:43]
  s_lshl_b32 s50, s7, 6
  s_lshl_b32 s51, s72, 5
  s_add_u32 s50, s50, s51
  v_add_u32 v22, s50, v16
  v_lshlrev_b32 v22, 1, v22
  global_load_ushort v178, v22, s[32:33]
  v_lshlrev_b32 v23, 4, v1
  s_xor_b32 s50, s3, 1
  s_lshl_b32 s51, s50, 2
  s_add_u32 s51, s51, s3
  s_lshl_b32 s51, s51, 12
  s_add_u32 s51, s51, 32768
  v_add_u32 v24, s51, v23
  s_lshl_b32 s51, s3, 2
  s_add_u32 s51, s51, s50
  s_lshl_b32 s51, s51, 12
  s_add_u32 s51, s51, 32768
  v_add_u32 v27, s51, v23
  s_xor_b32 s50, s3, 2
  s_lshl_b32 s51, s50, 2
  s_add_u32 s51, s51, s3
  s_lshl_b32 s51, s51, 12
  s_add_u32 s51, s51, 32768
  v_add_u32 v25, s51, v23
  s_lshl_b32 s51, s3, 2
  s_add_u32 s51, s51, s50
  s_lshl_b32 s51, s51, 12
  s_add_u32 s51, s51, 32768
  v_add_u32 v28, s51, v23
  s_xor_b32 s50, s3, 3
  s_lshl_b32 s51, s50, 2
  s_add_u32 s51, s51, s3
  s_lshl_b32 s51, s51, 12
  s_add_u32 s51, s51, 32768
  v_add_u32 v26, s51, v23
  s_lshl_b32 s51, s3, 2
  s_add_u32 s51, s51, s50
  s_lshl_b32 s51, s51, 12
  s_add_u32 s51, s51, 32768
  v_add_u32 v29, s51, v23
  s_waitcnt vmcnt(16)
  s_barrier
  s_cmp_lg_u32 s3, 0
  s_cbranch_scc1 L_sig20
  s_lshl_b32 s50, s35, 6
  s_add_u32 s50, s50, 13694976
  v_mov_b32 v252, s50
  v_mov_b32 v253, s75
  v_cmp_eq_u32 vcc, 0, v1
  s_and_saveexec_b64 s[50:51], vcc
  s_cbranch_execz L_sg221
  buffer_store_dword v253, v252, s[52:55], 0 offen sc1
L_sg221:
  s_mov_b64 exec, s[50:51]
L_sig20:
  s_lshl_b32 s74, s7, 5
  s_waitcnt vmcnt(15)
  s_cmp_lg_u32 s3, 0
  s_cbranch_scc1 L_pco23
  s_mov_b32 s50, 0
L_pc22:
  v_xor_b32 v248, s75, v248
  v_cmp_ne_u32 vcc, 0, v248
  s_add_u32 s50, s50, 1
  s_cmp_ge_u32 s50, 131072
  s_cbranch_scc1 L_pco23
  s_cbranch_vccz L_pco23
  s_sleep 4
  buffer_load_dword v248, v241, s[52:55], 0 offen sc1
  s_waitcnt vmcnt(0)
  s_branch L_pc22
L_pco23:
  s_barrier
  buffer_load_dwordx4 v[128:131], v4, s[52:55], s10 offen sc1
  s_add_u32 s10, s10, 1024
  buffer_load_dwordx4 v[136:139], v4, s[52:55], s10 offen sc1
  s_add_u32 s10, s10, 1024
  buffer_load_dwordx4 v[144:147], v4, s[52:55], s10 offen sc1
  s_add_u32 s10, s10, 1024
  buffer_load_dwordx4 v[152:155], v4, s[52:55], s10 offen sc1
  s_add_u32 s10, s10, 1024
  s_waitcnt vmcnt(3)
  ds_read_b64_tr_b16 v[32:33], v6 offset:0
  ds_read_b64_tr_b16 v[34:35], v6 offset:512
  ds_read_b64_tr_b16 v[36:37], v7 offset:0
  ds_read_b64_tr_b16 v[38:39], v7 offset:512
  s_waitcnt vmcnt(2) lgkmcnt(0)
  ds_read_b64_tr_b16 v[40:41], v6 offset:2048
  ds_read_b64_tr_b16 v[42:43], v6 offset:2560
  ds_read_b64_tr_b16 v[44:45], v7 offset:2048
  ds_read_b64_tr_b16 v[46:47], v7 offset:2560
  s_add_u32 m0, s13, 0
  s_nop 0
  buffer_load_dwordx4 v2, s[56:59], s8 offen  lds
  buffer_load_dwordx4 v3, s[56:59], s8 offen offset:1024  lds
  s_add_u32 s8, s8, 65536
  v_mfma_f32_32x32x16_bf16 v[64:79], v[32:35], v[128:131], 0
  v_mfma_f32_32x32x16_bf16 v[96:111], v[36:39], v[128:131], 0
  buffer_load_dwordx4 v[128:131], v4, s[52:55], s10 offen sc1
  s_add_u32 s10, s10, 1024
  s_waitcnt vmcnt(4) lgkmcnt(0)
  ds_read_b64_tr_b16 v[32:33], v6 offset:4096
  ds_read_b64_tr_b16 v[34:35], v6 offset:4608
  ds_read_b64_tr_b16 v[36:37], v7 offset:4096
  ds_read_b64_tr_b16 v[38:39], v7 offset:4608
  s_add_u32 m0, s13, 2048
  s_nop 0
  buffer_load_dwordx4 v2, s[56:59], s8 offen  lds
  buffer_load_dwordx4 v3, s[56:59], s8 offen offset:1024  lds
  s_add_u32 s8, s8, 65536
  v_mfma_f32_32x32x16_bf16 v[64:79], v[40:43], v[136:139], v[64:79]
  v_mfma_f32_32x32x16_bf16 v[96:111], v[44:47], v[136:139], v[96:111]
  buffer_load_dwordx4 v[136:139], v4, s[52:55], s10 offen sc1
  s_add_u32 s10, s10, 1024
  s_waitcnt vmcnt(6) lgkmcnt(0)
  ds_read_b64_tr_b16 v[40:41], v6 offset:6144
  ds_read_b64_tr_b16 v[42:43], v6 offset:6656
  ds_read_b64_tr_b16 v[44:45], v7 offset:6144
  ds_read_b64_tr_b16 v[46:47], v7 offset:6656
  s_add_u32 m0, s13, 4096
  s_nop 0
  buffer_load_dwordx4 v2, s[56:59], s8 offen  lds
  buffer_load_dwordx4 v3, s[56:59], s8 offen offset:1024  lds
  s_add_u32 s8, s8, 65536
  v_mfma_f32_32x32x16_bf16 v[64:79], v[32:35], v[144:147], v[64:79]
  v_mfma_f32_32x32x16_bf16 v[96:111], v[36:39], v[144:147], v[96:111]
  buffer_load_dwordx4 v[144:147], v4, s[52:55], s10 offen sc1
  s_add_u32 s10, s10, 1024
  s_and_b32 s50, s3, 1
  s_lshl_b32 s50, s50, 4
  v_lshlrev_b32 v20, 3, v18
  v_add_u32 v20, s50, v20
  v_sub_u32 v20, v16, v20
  v_and_b32 v21, 1, v20
  v_lshlrev_b32 v21, 4, v21
  v_lshlrev_b32 v22, v21, v178
  v_mov_b32 v19, 0x3f80
  v_lshlrev_b32 v19, v21, v19
  v_lshrrev_b32 v20, 1, v20
  v_cmp_eq_u32 vcc, 0, v20
  s_nop 1
  v_cndmask_b32 v180, 0, v22, vcc
  v_cndmask_b32 v184, 0, v19, vcc
  v_cmp_eq_u32 vcc, 1, v20
  s_nop 1
  v_cndmask_b32 v181, 0, v22, vcc
  v_cndmask_b32 v185, 0, v19, vcc
  v_cmp_eq_u32 vcc, 2, v20
  s_nop 1
  v_cndmask_b32 v182, 0, v22, vcc
  v_cndmask_b32 v186, 0, v19, vcc
  v_cmp_eq_u32 vcc, 3, v20
  s_nop 1
  v_cndmask_b32 v183, 0, v22, vcc
  v_cndmask_b32 v187, 0, v19, vcc
  v_cmp_gt_u32 vcc, 32, v1
  s_cmp_eq_u32 s3, 0
  s_cselect_b64 s[50:51], -1, 0
  s_and_b64 vcc, vcc, s[50:51]
  s_nop 1
  v_cndmask_b32 v188, 0, v176, vcc
  v_cndmask_b32 v192, 0, v177, vcc
  v_mov_b32 v189, 0
  v_mov_b32 v193, 0
  v_mov_b32 v190, 0
  v_mov_b32 v194, 0
  v_mov_b32 v191, 0
  v_mov_b32 v195, 0
  v_mov_b32 v196, 0x3f80
  v_mov_b32 v197, 0
  v_mov_b32 v198, 0
  v_mov_b32 v199, 0
  s_nop 1
  s_lshr_b32 s50, s3, 1
  s_cmp_lg_u32 s50, s34
  s_cbranch_scc1 L_exth24
  v_mfma_f32_32x32x16_bf16 v[64:79], v[160:163], v[180:183], v[64:79]
  v_mfma_f32_32x32x16_bf16 v[64:79], v[168:171], v[184:187], v[64:79]
  v_mfma_f32_32x32x16_bf16 v[96:111], v[164:167], v[180:183], v[96:111]
  v_mfma_f32_32x32x16_bf16 v[96:111], v[172:175], v[184:187], v[96:111]
L_exth24:
  v_mfma_f32_32x32x16_bf16 v[64:79], v[188:191], v[196:199], v[64:79]
  v_mfma_f32_32x32x16_bf16 v[96:111], v[192:195], v[196:199], v[96:111]
  s_waitcnt vmcnt(6) lgkmcnt(0)
  ds_read_b64_tr_b16 v[32:33], v6 offset:0
  ds_read_b64_tr_b16 v[34:35], v6 offset:512
  ds_read_b64_tr_b16 v[36:37], v7 offset:0
  ds_read_b64_tr_b16 v[38:39], v7 offset:512
  s_add_u32 m0, s13, 6144
  s_nop 0
  buffer_load_dwordx4 v2, s[56:59], s8 offen  lds
  buffer_load_dwordx4 v3, s[56:59], s8 offen offset:1024  lds
  s_add_u32 s8, s8, 65536
  v_mfma_f32_32x32x16_bf16 v[64:79], v[40:43], v[152:155], v[64:79]
  v_mfma_f32_32x32x16_bf16 v[96:111], v[44:47], v[152:155], v[96:111]
  buffer_load_dwordx4 v[152:155], v4, s[52:55], s10 offen sc1
  s_add_u32 s10, s10, 1024
  s_waitcnt vmcnt(6) lgkmcnt(0)
  ds_read_b64_tr_b16 v[40:41], v6 offset:2048
  ds_read_b64_tr_b16 v[42:43], v6 offset:2560
  ds_read_b64_tr_b16 v[44:45], v7 offset:2048
  ds_read_b64_tr_b16 v[46:47], v7 offset:2560
  s_add_u32 m0, s13, 0
  s_nop 0
  buffer_load_dwordx4 v2, s[56:59], s8 offen  lds
  buffer_load_dwordx4 v3, s[56:59], s8 offen offset:1024  lds
  s_add_u32 s8, s8, 65536
  v_mfma_f32_32x32x16_bf16 v[64:79], v[32:35], v[128:131], v[64:79]
  v_mfma_f32_32x32x16_bf16 v[96:111], v[36:39], v[128:131], v[96:111]
  buffer_load_dwordx4 v[128:131], v4, s[52:55], s10 offen sc1
  s_add_u32 s10, s10, 1024
  s_waitcnt vmcnt(6) lgkmcnt(0)
  ds_read_b64_tr_b16 v[32:33], v6 offset:4096
  ds_read_b64_tr_b16 v[34:35], v6 offset:4608
  ds_read_b64_tr_b16 v[36:37], v7 offset:4096
  ds_read_b64_tr_b16 v[38:39], v7 offset:4608
  s_add_u32 m0, s13, 2048
  s_nop 0
  buffer_load_dwordx4 v2, s[56:59], s8 offen  lds
  buffer_load_dwordx4 v3, s[56:59], s8 offen offset:1024  lds
  s_add_u32 s8, s8, 65536
  v_mfma_f32_32x32x16_bf16 v[64:79], v[40:43], v[136:139], v[64:79]
  v_mfma_f32_32x32x16_bf16 v[96:111], v[44:47], v[136:139], v[96:111]
  buffer_load_dwordx4 v[136:139], v4, s[52:55], s10 offen sc1
  s_add_u32 s10, s10, 1024
  s_waitcnt vmcnt(6) lgkmcnt(0)
  ds_read_b64_tr_b16 v[40:41], v6 offset:6144
  ds_read_b64_tr_b16 v[42:43], v6 offset:6656
  ds_read_b64_tr_b16 v[44:45], v7 offset:6144
  ds_read_b64_tr_b16 v[46:47], v7 offset:6656
  s_add_u32 m0, s13, 4096
  s_nop 0
  buffer_load_dwordx4 v2, s[56:59], s8 offen  lds
  buffer_load_dwordx4 v3, s[56:59], s8 offen offset:1024  lds
  s_add_u32 s8, s8, 65536
  v_mfma_f32_32x32x16_bf16 v[64:79], v[32:35], v[144:147], v[64:79]
  v_mfma_f32_32x32x16_bf16 v[96:111], v[36:39], v[144:147], v[96:111]
  buffer_load_dwordx4 v[144:147], v4, s[52:55], s10 offen sc1
  s_add_u32 s10, s10, 1024
  s_waitcnt vmcnt(6) lgkmcnt(0)
  ds_read_b64_tr_b16 v[32:33], v6 offset:0
  ds_read_b64_tr_b16 v[34:35], v6 offset:512
  ds_read_b64_tr_b16 v[36:37], v7 offset:0
  ds_read_b64_tr_b16 v[38:39], v7 offset:512
  s_add_u32 m0, s13, 6144
  s_nop 0
  buffer_load_dwordx4 v2, s[56:59], s8 offen  lds
  buffer_load_dwordx4 v3, s[56:59], s8 offen offset:1024  lds
  s_add_u32 s8, s8, 65536
  v_mfma_f32_32x32x16_bf16 v[64:79], v[40:43], v[152:155], v[64:79]
  v_mfma_f32_32x32x16_bf16 v[96:111], v[44:47], v[152:155], v[96:111]
  buffer_load_dwordx4 v[152:155], v4, s[52:55], s10 offen sc1
  s_add_u32 s10, s10, 1024
  s_waitcnt vmcnt(6) lgkmcnt(0)
  ds_read_b64_tr_b16 v[40:41], v6 offset:2048
  ds_read_b64_tr_b16 v[42:43], v6 offset:2560
  ds_read_b64_tr_b16 v[44:45], v7 offset:2048
  ds_read_b64_tr_b16 v[46:47], v7 offset:2560
  s_add_u32 m0, s13, 0
  s_nop 0
  buffer_load_dwordx4 v2, s[56:59], s8 offen  lds
  buffer_load_dwordx4 v3, s[56:59], s8 offen offset:1024  lds
  s_add_u32 s8, s8, 65536
  v_mfma_f32_32x32x16_bf16 v[64:79], v[32:35], v[128:131], v[64:79]
  v_mfma_f32_32x32x16_bf16 v[96:111], v[36:39], v[128:131], v[96:111]
  buffer_load_dwordx4 v[128:131], v4, s[52:55], s10 offen sc1
  s_add_u32 s10, s10, 1024
  s_waitcnt vmcnt(6) lgkmcnt(0)
  ds_read_b64_tr_b16 v[32:33], v6 offset:4096
  ds_read_b64_tr_b16 v[34:35], v6 offset:4608
  ds_read_b64_tr_b16 v[36:37], v7 offset:4096
  ds_read_b64_tr_b16 v[38:39], v7 offset:4608
  s_add_u32 m0, s13, 2048
  s_nop 0
  buffer_load_dwordx4 v2, s[56:59], s8 offen  lds
  buffer_load_dwordx4 v3, s[56:59], s8 offen offset:1024  lds
  s_add_u32 s8, s8, 65536
  v_mfma_f32_32x32x16_bf16 v[64:79], v[40:43], v[136:139], v[64:79]
  v_mfma_f32_32x32x16_bf16 v[96:111], v[44:47], v[136:139], v[96:111]
  buffer_load_dwordx4 v[136:139], v4, s[52:55], s10 offen sc1
  s_add_u32 s10, s10, 1024
  s_waitcnt vmcnt(6) lgkmcnt(0)
  ds_read_b64_tr_b16 v[40:41], v6 offset:6144
  ds_read_b64_tr_b16 v[42:43], v6 offset:6656
  ds_read_b64_tr_b16 v[44:45], v7 offset:6144
  ds_read_b64_tr_b16 v[46:47], v7 offset:6656
  s_add_u32 m0, s13, 4096
  s_nop 0
  buffer_load_dwordx4 v2, s[56:59], s8 offen  lds
  buffer_load_dwordx4 v3, s[56:59], s8 offen offset:1024  lds
  s_add_u32 s8, s8, 65536
  v_mfma_f32_32x32x16_bf16 v[64:79], v[32:35], v[144:147], v[64:79]
  v_mfma_f32_32x32x16_bf16 v[96:111], v[36:39], v[144:147], v[96:111]
  buffer_load_dwordx4 v[144:147], v4, s[52:55], s10 offen sc1
  s_add_u32 s10, s10, 1024
  s_waitcnt vmcnt(6) lgkmcnt(0)
  ds_read_b64_tr_b16 v[32:33], v6 offset:0
  ds_read_b64_tr_b16 v[34:35], v6 offset:512
  ds_read_b64_tr_b16 v[36:37], v7 offset:0
  ds_read_b64_tr_b16 v[38:39], v7 offset:512
  s_add_u32 m0, s13, 6144
  s_nop 0
  buffer_load_dwordx4 v2, s[56:59], s8 offen  lds
  buffer_load_dwordx4 v3, s[56:59], s8 offen offset:1024  lds
  s_add_u32 s8, s8, 65536
  v_mfma_f32_32x32x16_bf16 v[64:79], v[40:43], v[152:155], v[64:79]
  v_mfma_f32_32x32x16_bf16 v[96:111], v[44:47], v[152:155], v[96:111]
  buffer_load_dwordx4 v[152:155], v4, s[52:55], s10 offen sc1
  s_add_u32 s10, s10, 1024
  s_waitcnt vmcnt(6) lgkmcnt(0)
  ds_read_b64_tr_b16 v[40:41], v6 offset:2048
  ds_read_b64_tr_b16 v[42:43], v6 offset:2560
  ds_read_b64_tr_b16 v[44:45], v7 offset:2048
  ds_read_b64_tr_b16 v[46:47], v7 offset:2560
  s_add_u32 m0, s13, 0
  s_nop 0
  buffer_load_dwordx4 v2, s[56:59], s8 offen  lds
  buffer_load_dwordx4 v3, s[56:59], s8 offen offset:1024  lds
  s_add_u32 s8, s8, 65536
  v_mfma_f32_32x32x16_bf16 v[64:79], v[32:35], v[128:131], v[64:79]
  v_mfma_f32_32x32x16_bf16 v[96:111], v[36:39], v[128:131], v[96:111]
  buffer_load_dwordx4 v[128:131], v4, s[52:55], s10 offen sc1
  s_add_u32 s10, s10, 1024
  s_waitcnt vmcnt(6) lgkmcnt(0)
  ds_read_b64_tr_b16 v[32:33], v6 offset:4096
  ds_read_b64_tr_b16 v[34:35], v6 offset:4608
  ds_read_b64_tr_b16 v[36:37], v7 offset:4096
  ds_read_b64_tr_b16 v[38:39], v7 offset:4608
  s_add_u32 m0, s13, 2048
  s_nop 0
  buffer_load_dwordx4 v2, s[56:59], s8 offen  lds
  buffer_load_dwordx4 v3, s[56:59], s8 offen offset:1024  lds
  s_add_u32 s8, s8, 65536
  v_mfma_f32_32x32x16_bf16 v[64:79], v[40:43], v[136:139], v[64:79]
  v_mfma_f32_32x32x16_bf16 v[96:111], v[44:47], v[136:139], v[96:111]
  buffer_load_dwordx4 v[136:139], v4, s[52:55], s10 offen sc1
  s_add_u32 s10, s10, 1024
  s_waitcnt vmcnt(6) lgkmcnt(0)
  ds_read_b64_tr_b16 v[40:41], v6 offset:6144
  ds_read_b64_tr_b16 v[42:43], v6 offset:6656
  ds_read_b64_tr_b16 v[44:45], v7 offset:6144
  ds_read_b64_tr_b16 v[46:47], v7 offset:6656
  s_add_u32 m0, s13, 4096
  s_nop 0
  buffer_load_dwordx4 v2, s[56:59], s8 offen  lds
  buffer_load_dwordx4 v3, s[56:59], s8 offen offset:1024  lds
  s_add_u32 s8, s8, 65536
  v_mfma_f32_32x32x16_bf16 v[64:79], v[32:35], v[144:147], v[64:79]
  v_mfma_f32_32x32x16_bf16 v[96:111], v[36:39], v[144:147], v[96:111]
  buffer_load_dwordx4 v[144:147], v4, s[52:55], s10 offen sc1
  s_add_u32 s10, s10, 1024
  s_waitcnt vmcnt(6) lgkmcnt(0)
  ds_read_b64_tr_b16 v[32:33], v6 offset:0
  ds_read_b64_tr_b16 v[34:35], v6 offset:512
  ds_read_b64_tr_b16 v[36:37], v7 offset:0
  ds_read_b64_tr_b16 v[38:39], v7 offset:512
  s_add_u32 m0, s13, 6144
  s_nop 0
  buffer_load_dwordx4 v2, s[56:59], s8 offen  lds
  buffer_load_dwordx4 v3, s[56:59], s8 offen offset:1024  lds
  s_add_u32 s8, s8, 65536
  v_mfma_f32_32x32x16_bf16 v[64:79], v[40:43], v[152:155], v[64:79]
  v_mfma_f32_32x32x16_bf16 v[96:111], v[44:47], v[152:155], v[96:111]
  buffer_load_dwordx4 v[152:155], v4, s[52:55], s10 offen sc1
  s_add_u32 s10, s10, 1024
  s_waitcnt vmcnt(6) lgkmcnt(0)
  ds_read_b64_tr_b16 v[40:41], v6 offset:2048
  ds_read_b64_tr_b16 v[42:43], v6 offset:2560
  ds_read_b64_tr_b16 v[44:45], v7 offset:2048
  ds_read_b64_tr_b16 v[46:47], v7 offset:2560
  s_add_u32 m0, s13, 0
  s_nop 0
  buffer_load_dwordx4 v2, s[56:59], s8 offen  lds
  buffer_load_dwordx4 v3, s[56:59], s8 offen offset:1024  lds
  s_add_u32 s8, s8, 65536
  v_mfma_f32_32x32x16_bf16 v[64:79], v[32:35], v[128:131], v[64:79]
  v_mfma_f32_32x32x16_bf16 v[96:111], v[36:39], v[128:131], v[96:111]
  buffer_load_dwordx4 v[128:131], v4, s[52:55], s10 offen sc1
  s_add_u32 s10, s10, 1024
  s_waitcnt vmcnt(6) lgkmcnt(0)
  ds_read_b64_tr_b16 v[32:33], v6 offset:4096
  ds_read_b64_tr_b16 v[34:35], v6 offset:4608
  ds_read_b64_tr_b16 v[36:37], v7 offset:4096
  ds_read_b64_tr_b16 v[38:39], v7 offset:4608
  s_add_u32 m0, s13, 2048
  s_nop 0
  buffer_load_dwordx4 v2, s[56:59], s8 offen  lds
  buffer_load_dwordx4 v3, s[56:59], s8 offen offset:1024  lds
  s_add_u32 s8, s8, 65536
  v_mfma_f32_32x32x16_bf16 v[64:79], v[40:43], v[136:139], v[64:79]
  v_mfma_f32_32x32x16_bf16 v[96:111], v[44:47], v[136:139], v[96:111]
  buffer_load_dwordx4 v[136:139], v4, s[52:55], s10 offen sc1
  s_add_u32 s10, s10, 1024
  s_waitcnt vmcnt(6) lgkmcnt(0)
  ds_read_b64_tr_b16 v[40:41], v6 offset:6144
  ds_read_b64_tr_b16 v[42:43], v6 offset:6656
  ds_read_b64_tr_b16 v[44:45], v7 offset:6144
  ds_read_b64_tr_b16 v[46:47], v7 offset:6656
  s_add_u32 m0, s13, 4096
  s_nop 0
  buffer_load_dwordx4 v2, s[56:59], s8 offen  lds
  buffer_load_dwordx4 v3, s[56:59], s8 offen offset:1024  lds
  s_add_u32 s8, s8, 65536
  v_mfma_f32_32x32x16_bf16 v[64:79], v[32:35], v[144:147], v[64:79]
  v_mfma_f32_32x32x16_bf16 v[96:111], v[36:39], v[144:147], v[96:111]
  buffer_load_dwordx4 v[144:147], v4, s[52:55], s10 offen sc1
  s_add_u32 s10, s10, 1024
  s_lshr_b32 s74, s6, 2
  s_lshl_b32 s74, s74, 4
  v_min_u32 v242, 6, v1
  v_add_u32 v242, s74, v242
  v_lshlrev_b32 v242, 6, v242
  s_cmp_eq_u32 s3, 0
  s_mov_b32 s51, 2147483648
  s_cselect_b32 s50, 13694976, s51
  v_add_u32 v242, s50, v242
  buffer_load_dword v249, v242, s[52:55], 0 offen sc1
  s_waitcnt vmcnt(7) lgkmcnt(0)
  ds_read_b64_tr_b16 v[32:33], v6 offset:0
  ds_read_b64_tr_b16 v[34:35], v6 offset:512
  ds_read_b64_tr_b16 v[36:37], v7 offset:0
  ds_read_b64_tr_b16 v[38:39], v7 offset:512
  s_add_u32 m0, s13, 6144
  s_nop 0
  buffer_load_dwordx4 v2, s[56:59], s8 offen  lds
  buffer_load_dwordx4 v3, s[56:59], s8 offen offset:1024  lds
  s_add_u32 s8, s8, 65536
  v_mfma_f32_32x32x16_bf16 v[64:79], v[40:43], v[152:155], v[64:79]
  v_mfma_f32_32x32x16_bf16 v[96:111], v[44:47], v[152:155], v[96:111]
  buffer_load_dwordx4 v[152:155], v4, s[52:55], s10 offen sc1
  s_add_u32 s10, s10, 1024
  s_waitcnt vmcnt(7) lgkmcnt(0)
  ds_read_b64_tr_b16 v[40:41], v6 offset:2048
  ds_read_b64_tr_b16 v[42:43], v6 offset:2560
  ds_read_b64_tr_b16 v[44:45], v7 offset:2048
  ds_read_b64_tr_b16 v[46:47], v7 offset:2560
  s_add_u32 m0, s13, 0
  s_nop 0
  buffer_load_dwordx4 v2, s[56:59], s8 offen  lds
  buffer_load_dwordx4 v3, s[56:59], s8 offen offset:1024  lds
  s_add_u32 s8, s8, 65536
  v_mfma_f32_32x32x16_bf16 v[64:79], v[32:35], v[128:131], v[64:79]
  v_mfma_f32_32x32x16_bf16 v[96:111], v[36:39], v[128:131], v[96:111]
  buffer_load_dwordx4 v[128:131], v4, s[52:55], s10 offen sc1
  s_add_u32 s10, s10, 1024
  s_waitcnt vmcnt(7) lgkmcnt(0)
  ds_read_b64_tr_b16 v[32:33], v6 offset:4096
  ds_read_b64_tr_b16 v[34:35], v6 offset:4608
  ds_read_b64_tr_b16 v[36:37], v7 offset:4096
  ds_read_b64_tr_b16 v[38:39], v7 offset:4608
  s_add_u32 m0, s13, 2048
  s_nop 0
  buffer_load_dwordx4 v2, s[56:59], s8 offen  lds
  buffer_load_dwordx4 v3, s[56:59], s8 offen offset:1024  lds
  s_add_u32 s8, s8, 65536
  v_mfma_f32_32x32x16_bf16 v[64:79], v[40:43], v[136:139], v[64:79]
  v_mfma_f32_32x32x16_bf16 v[96:111], v[44:47], v[136:139], v[96:111]
  buffer_load_dwordx4 v[136:139], v4, s[52:55], s10 offen sc1
  s_add_u32 s10, s10, 1024
  s_waitcnt vmcnt(6) lgkmcnt(0)
  ds_read_b64_tr_b16 v[40:41], v6 offset:6144
  ds_read_b64_tr_b16 v[42:43], v6 offset:6656
  ds_read_b64_tr_b16 v[44:45], v7 offset:6144
  ds_read_b64_tr_b16 v[46:47], v7 offset:6656
  s_add_u32 m0, s13, 4096
  s_nop 0
  buffer_load_dwordx4 v2, s[56:59], s8 offen  lds
  buffer_load_dwordx4 v3, s[56:59], s8 offen offset:1024  lds
  s_add_u32 s8, s8, 65536
  v_mfma_f32_32x32x16_bf16 v[64:79], v[32:35], v[144:147], v[64:79]
  v_mfma_f32_32x32x16_bf16 v[96:111], v[36:39], v[144:147], v[96:111]
  buffer_load_dwordx4 v[144:147], v4, s[52:55], s10 offen sc1
  s_add_u32 s10, s10, 1024
  s_waitcnt vmcnt(6) lgkmcnt(0)
  ds_read_b64_tr_b16 v[32:33], v6 offset:0
  ds_read_b64_tr_b16 v[34:35], v6 offset:512
  ds_read_b64_tr_b16 v[36:37], v7 offset:0
  ds_read_b64_tr_b16 v[38:39], v7 offset:512
  s_add_u32 m0, s13, 6144
  s_nop 0
  buffer_load_dwordx4 v2, s[56:59], s8 offen  lds
  buffer_load_dwordx4 v3, s[56:59], s8 offen offset:1024  lds
  s_add_u32 s8, s8, 65536
  v_mfma_f32_32x32x16_bf16 v[64:79], v[40:43], v[152:155], v[64:79]
  v_mfma_f32_32x32x16_bf16 v[96:111], v[44:47], v[152:155], v[96:111]
  buffer_load_dwordx4 v[152:155], v4, s[52:55], s10 offen sc1
  s_add_u32 s10, s10, 1024
  s_waitcnt vmcnt(6) lgkmcnt(0)
  ds_read_b64_tr_b16 v[40:41], v6 offset:2048
  ds_read_b64_tr_b16 v[42:43], v6 offset:2560
  ds_read_b64_tr_b16 v[44:45], v7 offset:2048
  ds_read_b64_tr_b16 v[46:47], v7 offset:2560
  s_cmp_lg_u32 s3, 0
  s_cbranch_scc1 L_pco26
  s_mov_b32 s50, 0
L_pc25:
  v_xor_b32 v249, s75, v249
  v_cmp_ne_u32 vcc, 0, v249
  s_add_u32 s50, s50, 1
  s_cmp_ge_u32 s50, 131072
  s_cbranch_scc1 L_pco26
  s_cbranch_vccz L_pco26
  s_sleep 4
  buffer_load_dword v249, v242, s[52:55], 0 offen sc1
  s_waitcnt vmcnt(0)
  s_branch L_pc25
L_pco26:
  s_barrier
  s_add_u32 m0, s13, 0
  s_nop 0
  buffer_load_dwordx4 v8, s[52:55], s14 offen sc1 lds
  s_add_u32 m0, m0, 896
  s_nop 0
  buffer_load_dwordx4 v8, s[52:55], s14 offen offset:128 sc1 lds
  s_add_u32 s14, s14, 256
  v_mfma_f32_32x32x16_bf16 v[64:79], v[32:35], v[128:131], v[64:79]
  v_mfma_f32_32x32x16_bf16 v[96:111], v[36:39], v[128:131], v[96:111]
  buffer_load_dwordx4 v[128:131], v4, s[52:55], s15 offen sc1
  s_add_u32 s15, s15, 1024
  s_waitcnt vmcnt(6) lgkmcnt(0)
  ds_read_b64_tr_b16 v[32:33], v6 offset:4096
  ds_read_b64_tr_b16 v[34:35], v6 offset:4608
  ds_read_b64_tr_b16 v[36:37], v7 offset:4096
  ds_read_b64_tr_b16 v[38:39], v7 offset:4608
  s_add_u32 m0, s13, 2048
  s_nop 0
  buffer_load_dwordx4 v8, s[52:55], s14 offen sc1 lds
  s_add_u32 m0, m0, 896
  s_nop 0
  buffer_load_dwordx4 v8, s[52:55], s14 offen offset:128 sc1 lds
  s_add_u32 s14, s14, 256
  v_mfma_f32_32x32x16_bf16 v[64:79], v[40:43], v[136:139], v[64:79]
  v_mfma_f32_32x32x16_bf16 v[96:111], v[44:47], v[136:139], v[96:111]
  buffer_load_dwordx4 v[136:139], v4, s[52:55], s15 offen sc1
  s_add_u32 s15, s15, 1024
  s_waitcnt vmcnt(6) lgkmcnt(0)
  ds_read_b64_tr_b16 v[40:41], v6 offset:6144
  ds_read_b64_tr_b16 v[42:43], v6 offset:6656
  ds_read_b64_tr_b16 v[44:45], v7 offset:6144
  ds_read_b64_tr_b16 v[46:47], v7 offset:6656
  s_add_u32 m0, s13, 4096
  s_nop 0
  buffer_load_dwordx4 v8, s[52:55], s14 offen sc1 lds
  s_add_u32 m0, m0, 896
  s_nop 0
  buffer_load_dwordx4 v8, s[52:55], s14 offen offset:128 sc1 lds
  s_add_u32 s14, s14, 256
  v_mfma_f32_32x32x16_bf16 v[64:79], v[32:35], v[144:147], v[64:79]
  v_mfma_f32_32x32x16_bf16 v[96:111], v[36:39], v[144:147], v[96:111]
  buffer_load_dwordx4 v[144:147], v4, s[52:55], s15 offen sc1
  s_add_u32 s15, s15, 1024
  s_waitcnt vmcnt(6) lgkmcnt(0)
  ds_read_b64_tr_b16 v[32:33], v10 offset:0
  ds_read_b64_tr_b16 v[34:35], v11 offset:0
  ds_read_b64_tr_b16 v[36:37], v12 offset:0
  ds_read_b64_tr_b16 v[38:39], v13 offset:0
  s_add_u32 m0, s13, 6144
  s_nop 0
  buffer_load_dwordx4 v8, s[52:55], s14 offen sc1 lds
  s_add_u32 m0, m0, 896
  s_nop 0
  buffer_load_dwordx4 v8, s[52:55], s14 offen offset:128 sc1 lds
  s_add_u32 s14, s14, 256
  v_mfma_f32_32x32x16_bf16 v[64:79], v[40:43], v[152:155], v[64:79]
  v_mfma_f32_32x32x16_bf16 v[96:111], v[44:47], v[152:155], v[96:111]
  buffer_load_dwordx4 v[152:155], v4, s[52:55], s15 offen sc1
  s_add_u32 s15, s15, 1024
  s_waitcnt vmcnt(6) lgkmcnt(0)
  ds_read_b64_tr_b16 v[40:41], v10 offset:2048
  ds_read_b64_tr_b16 v[42:43], v11 offset:2048
  ds_read_b64_tr_b16 v[44:45], v12 offset:2048
  ds_read_b64_tr_b16 v[46:47], v13 offset:2048
  s_add_u32 m0, s13, 0
  s_nop 0
  buffer_load_dwordx4 v8, s[52:55], s14 offen sc1 lds
  s_add_u32 m0, m0, 896
  s_nop 0
  buffer_load_dwordx4 v8, s[52:55], s14 offen offset:128 sc1 lds
  s_add_u32 s14, s14, 256
  v_mfma_f32_32x32x16_bf16 v[64:79], v[32:35], v[128:131], v[64:79]
  v_mfma_f32_32x32x16_bf16 v[96:111], v[36:39], v[128:131], v[96:111]
  buffer_load_dwordx4 v[128:131], v4, s[52:55], s15 offen sc1
  s_add_u32 s15, s15, 1024
  s_waitcnt vmcnt(6) lgkmcnt(0)
  ds_read_b64_tr_b16 v[32:33], v10 offset:4096
  ds_read_b64_tr_b16 v[34:35], v11 offset:4096
  ds_read_b64_tr_b16 v[36:37], v12 offset:4096
  ds_read_b64_tr_b16 v[38:39], v13 offset:4096
  s_add_u32 m0, s13, 2048
  s_nop 0
  buffer_load_dwordx4 v8, s[52:55], s14 offen sc1 lds
  s_add_u32 m0, m0, 896
  s_nop 0
  buffer_load_dwordx4 v8, s[52:55], s14 offen offset:128 sc1 lds
  s_add_u32 s14, s14, 256
  v_mfma_f32_32x32x16_bf16 v[64:79], v[40:43], v[136:139], v[64:79]
  v_mfma_f32_32x32x16_bf16 v[96:111], v[44:47], v[136:139], v[96:111]
  buffer_load_dwordx4 v[136:139], v4, s[52:55], s15 offen sc1
  s_add_u32 s15, s15, 1024
  s_waitcnt vmcnt(6) lgkmcnt(0)
  ds_read_b64_tr_b16 v[40:41], v10 offset:6144
  ds_read_b64_tr_b16 v[42:43], v11 offset:6144
  ds_read_b64_tr_b16 v[44:45], v12 offset:6144
  ds_read_b64_tr_b16 v[46:47], v13 offset:6144
  s_add_u32 m0, s13, 4096
  s_nop 0
  buffer_load_dwordx4 v8, s[52:55], s14 offen sc1 lds
  s_add_u32 m0, m0, 896
  s_nop 0
  buffer_load_dwordx4 v8, s[52:55], s14 offen offset:128 sc1 lds
  s_add_u32 s14, s14, 256
  v_mfma_f32_32x32x16_bf16 v[64:79], v[32:35], v[144:147], v[64:79]
  v_mfma_f32_32x32x16_bf16 v[96:111], v[36:39], v[144:147], v[96:111]
  buffer_load_dwordx4 v[144:147], v4, s[52:55], s15 offen sc1
  s_add_u32 s15, s15, 1024
  s_waitcnt vmcnt(6) lgkmcnt(0)
  ds_read_b64_tr_b16 v[32:33], v10 offset:0
  ds_read_b64_tr_b16 v[34:35], v11 offset:0
  ds_read_b64_tr_b16 v[36:37], v12 offset:0
  ds_read_b64_tr_b16 v[38:39], v13 offset:0
  s_add_u32 m0, s13, 6144
  s_nop 0
  buffer_load_dwordx4 v8, s[52:55], s14 offen sc1 lds
  s_add_u32 m0, m0, 896
  s_nop 0
  buffer_load_dwordx4 v8, s[52:55], s14 offen offset:128 sc1 lds
  s_add_u32 s14, s14, 256
  v_mfma_f32_32x32x16_bf16 v[64:79], v[40:43], v[152:155], v[64:79]
  v_mfma_f32_32x32x16_bf16 v[96:111], v[44:47], v[152:155], v[96:111]
  buffer_load_dwordx4 v[152:155], v4, s[52:55], s15 offen sc1
  s_add_u32 s15, s15, 1024
  s_waitcnt vmcnt(6) lgkmcnt(0)
  ds_read_b64_tr_b16 v[40:41], v10 offset:2048
  ds_read_b64_tr_b16 v[42:43], v11 offset:2048
  ds_read_b64_tr_b16 v[44:45], v12 offset:2048
  ds_read_b64_tr_b16 v[46:47], v13 offset:2048
  s_add_u32 m0, s13, 0
  s_nop 0
  buffer_load_dwordx4 v8, s[52:55], s14 offen sc1 lds
  s_add_u32 m0, m0, 896
  s_nop 0
  buffer_load_dwordx4 v8, s[52:55], s14 offen offset:128 sc1 lds
  s_add_u32 s14, s14, 256
  v_mfma_f32_32x32x16_bf16 v[64:79], v[32:35], v[128:131], v[64:79]
  v_mfma_f32_32x32x16_bf16 v[96:111], v[36:39], v[128:131], v[96:111]
  buffer_load_dwordx4 v[128:131], v4, s[52:55], s15 offen sc1
  s_add_u32 s15, s15, 1024
  s_waitcnt vmcnt(6) lgkmcnt(0)
  ds_read_b64_tr_b16 v[32:33], v10 offset:4096
  ds_read_b64_tr_b16 v[34:35], v11 offset:4096
  ds_read_b64_tr_b16 v[36:37], v12 offset:4096
  ds_read_b64_tr_b16 v[38:39], v13 offset:4096
  s_add_u32 m0, s13, 2048
  s_nop 0
  buffer_load_dwordx4 v8, s[52:55], s14 offen sc1 lds
  s_add_u32 m0, m0, 896
  s_nop 0
  buffer_load_dwordx4 v8, s[52:55], s14 offen offset:128 sc1 lds
  s_add_u32 s14, s14, 256
  v_mfma_f32_32x32x16_bf16 v[64:79], v[40:43], v[136:139], v[64:79]
  v_mfma_f32_32x32x16_bf16 v[96:111], v[44:47], v[136:139], v[96:111]
  buffer_load_dwordx4 v[136:139], v4, s[52:55], s15 offen sc1
  s_add_u32 s15, s15, 1024
  s_waitcnt vmcnt(6) lgkmcnt(0)
  ds_read_b64_tr_b16 v[40:41], v10 offset:6144
  ds_read_b64_tr_b16 v[42:43], v11 offset:6144
  ds_read_b64_tr_b16 v[44:45], v12 offset:6144
  ds_read_b64_tr_b16 v[46:47], v13 offset:6144
  s_add_u32 m0, s13, 4096
  s_nop 0
  buffer_load_dwordx4 v8, s[52:55], s14 offen sc1 lds
  s_add_u32 m0, m0, 896
  s_nop 0
  buffer_load_dwordx4 v8, s[52:55], s14 offen offset:128 sc1 lds
  s_add_u32 s14, s14, 256
  v_mfma_f32_32x32x16_bf16 v[64:79], v[32:35], v[144:147], v[64:79]
  v_mfma_f32_32x32x16_bf16 v[96:111], v[36:39], v[144:147], v[96:111]
  buffer_load_dwordx4 v[144:147], v4, s[52:55], s15 offen sc1
  s_add_u32 s15, s15, 1024
  v_lshrrev_b32 v30, 5, v1
  v_mul_u32_u24 v30, 7168, v30
  v_and_b32 v31, 31, v1
  v_lshl_add_u32 v30, v31, 2, v30
  s_lshl_b32 s72, s6, 6
  s_lshl_b32 s50, s3, 4
  s_add_u32 s72, s72, s50
  s_mul_i32 s72, s72, 1792
  s_lshl_b32 s50, s7, 8
  s_add_u32 s72, s72, s50
  s_lshl_b32 s50, s34, 7
  s_add_u32 s72, s72, s50
  s_waitcnt vmcnt(6) lgkmcnt(0)
  ds_read_b64_tr_b16 v[32:33], v10 offset:0
  ds_read_b64_tr_b16 v[34:35], v11 offset:0
  ds_read_b64_tr_b16 v[36:37], v12 offset:0
  ds_read_b64_tr_b16 v[38:39], v13 offset:0
  s_add_u32 m0, s13, 6144
  s_nop 0
  buffer_load_dwordx4 v8, s[52:55], s14 offen sc1 lds
  s_add_u32 m0, m0, 896
  s_nop 0
  buffer_load_dwordx4 v8, s[52:55], s14 offen offset:128 sc1 lds
  s_add_u32 s14, s14, 256
  v_mfma_f32_32x32x16_bf16 v[64:79], v[40:43], v[152:155], v[64:79]
  v_mfma_f32_32x32x16_bf16 v[96:111], v[44:47], v[152:155], v[96:111]
  buffer_load_dwordx4 v[152:155], v4, s[52:55], s15 offen sc1
  s_add_u32 s15, s15, 1024
  s_waitcnt vmcnt(6) lgkmcnt(0)
  ds_read_b64_tr_b16 v[40:41], v10 offset:2048
  ds_read_b64_tr_b16 v[42:43], v11 offset:2048
  ds_read_b64_tr_b16 v[44:45], v12 offset:2048
  ds_read_b64_tr_b16 v[46:47], v13 offset:2048
  s_add_u32 m0, s13, 0
  s_nop 0
  buffer_load_dwordx4 v8, s[52:55], s14 offen sc1 lds
  s_add_u32 m0, m0, 896
  s_nop 0
  buffer_load_dwordx4 v8, s[52:55], s14 offen offset:128 sc1 lds
  s_add_u32 s14, s14, 256
  v_mfma_f32_32x32x16_bf16 v[64:79], v[32:35], v[128:131], v[64:79]
  v_mfma_f32_32x32x16_bf16 v[96:111], v[36:39], v[128:131], v[96:111]
  buffer_load_dwordx4 v[128:131], v4, s[52:55], s15 offen sc1
  s_add_u32 s15, s15, 1024
  s_waitcnt vmcnt(6) lgkmcnt(0)
  ds_read_b64_tr_b16 v[32:33], v10 offset:4096
  ds_read_b64_tr_b16 v[34:35], v11 offset:4096
  ds_read_b64_tr_b16 v[36:37], v12 offset:4096
  ds_read_b64_tr_b16 v[38:39], v13 offset:4096
  s_add_u32 m0, s13, 2048
  s_nop 0
  buffer_load_dwordx4 v8, s[52:55], s14 offen sc1 lds
  s_add_u32 m0, m0, 896
  s_nop 0
  buffer_load_dwordx4 v8, s[52:55], s14 offen offset:128 sc1 lds
  s_add_u32 s14, s14, 256
  v_mfma_f32_32x32x16_bf16 v[64:79], v[40:43], v[136:139], v[64:79]
  v_mfma_f32_32x32x16_bf16 v[96:111], v[44:47], v[136:139], v[96:111]
  buffer_load_dwordx4 v[136:139], v4, s[52:55], s15 offen sc1
  s_add_u32 s15, s15, 1024
  s_waitcnt vmcnt(6) lgkmcnt(0)
  ds_read_b64_tr_b16 v[40:41], v10 offset:6144
  ds_read_b64_tr_b16 v[42:43], v11 offset:6144
  ds_read_b64_tr_b16 v[44:45], v12 offset:6144
  ds_read_b64_tr_b16 v[46:47], v13 offset:6144
  v_mfma_f32_32x32x16_bf16 v[64:79], v[32:35], v[144:147], v[64:79]
  v_mfma_f32_32x32x16_bf16 v[96:111], v[36:39], v[144:147], v[96:111]
  s_waitcnt vmcnt(3) lgkmcnt(0)
  ds_read_b64_tr_b16 v[32:33], v10 offset:0
  ds_read_b64_tr_b16 v[34:35], v11 offset:0
  ds_read_b64_tr_b16 v[36:37], v12 offset:0
  ds_read_b64_tr_b16 v[38:39], v13 offset:0
  v_mfma_f32_32x32x16_bf16 v[64:79], v[40:43], v[152:155], v[64:79]
  v_mfma_f32_32x32x16_bf16 v[96:111], v[44:47], v[152:155], v[96:111]
  s_waitcnt vmcnt(0) lgkmcnt(0)
  ds_read_b64_tr_b16 v[40:41], v10 offset:2048
  ds_read_b64_tr_b16 v[42:43], v11 offset:2048
  ds_read_b64_tr_b16 v[44:45], v12 offset:2048
  ds_read_b64_tr_b16 v[46:47], v13 offset:2048
  v_mfma_f32_32x32x16_bf16 v[64:79], v[32:35], v[128:131], v[64:79]
  v_mfma_f32_32x32x16_bf16 v[96:111], v[36:39], v[128:131], v[96:111]
  s_waitcnt lgkmcnt(0)
  v_mfma_f32_32x32x16_bf16 v[64:79], v[40:43], v[136:139], v[64:79]
  v_mfma_f32_32x32x16_bf16 v[96:111], v[44:47], v[136:139], v[96:111]
  s_nop 13
  ds_write_b128 v24, v[72:75] offset:0
  ds_write_b128 v24, v[76:79] offset:1024
  ds_write_b128 v25, v[96:99] offset:0
  ds_write_b128 v25, v[100:103] offset:1024
  ds_write_b128 v26, v[104:107] offset:0
  ds_write_b128 v26, v[108:111] offset:1024
  s_waitcnt lgkmcnt(0)
  s_barrier
  ds_read_b128 v[192:195], v27 offset:0
  ds_read_b128 v[196:199], v27 offset:1024
  ds_read_b128 v[208:211], v28 offset:0
  ds_read_b128 v[212:215], v28 offset:1024
  ds_read_b128 v[224:227], v29 offset:0
  ds_read_b128 v[228:231], v29 offset:1024
  s_waitcnt lgkmcnt(4)
  v_pk_add_f32 v[64:65], v[64:65], v[192:193]
  v_pk_add_f32 v[66:67], v[66:67], v[194:195]
  v_pk_add_f32 v[68:69], v[68:69], v[196:197]
  v_pk_add_f32 v[70:71], v[70:71], v[198:199]
  s_waitcnt lgkmcnt(2)
  v_pk_add_f32 v[64:65], v[64:65], v[208:209]
  v_pk_add_f32 v[66:67], v[66:67], v[210:211]
  v_pk_add_f32 v[68:69], v[68:69], v[212:213]
  v_pk_add_f32 v[70:71], v[70:71], v[214:215]
  s_waitcnt lgkmcnt(0)
  v_pk_add_f32 v[64:65], v[64:65], v[224:225]
  v_pk_add_f32 v[66:67], v[66:67], v[226:227]
  v_pk_add_f32 v[68:69], v[68:69], v[228:229]
  v_pk_add_f32 v[70:71], v[70:71], v[230:231]
  s_add_u32 s50, s72, 0
  buffer_store_dword v64, v30, s[64:67], s50 offen offset:0 nt
  s_add_u32 s50, s72, 1792
  buffer_store_dword v65, v30, s[64:67], s50 offen offset:0 nt
  s_add_u32 s50, s72, 3584
  buffer_store_dword v66, v30, s[64:67], s50 offen offset:0 nt
  s_add_u32 s50, s72, 5376
  buffer_store_dword v67, v30, s[64:67], s50 offen offset:0 nt
  s_add_u32 s50, s72, 14336
  buffer_store_dword v68, v30, s[64:67], s50 offen offset:0 nt
  s_add_u32 s50, s72, 16128
  buffer_store_dword v69, v30, s[64:67], s50 offen offset:0 nt
  s_add_u32 s50, s72, 17920
  buffer_store_dword v70, v30, s[64:67], s50 offen offset:0 nt
  s_add_u32 s50, s72, 19712
  buffer_store_dword v71, v30, s[64:67], s50 offen offset:0 nt
  s_branch L_fin
L_g2:
  s_mul_hi_u32 s50, s5, 613566757
  s_mul_i32 s51, s50, 7
  s_sub_u32 s7, s5, s51
  s_lshl_b32 s6, s4, 2
  s_add_u32 s6, s6, s50
  s_lshl_b32 s13, s3, 13
  s_lshr_b32 s14, s3, 1
  s_lshl_b32 s14, s14, 8
  s_lshl_b32 s50, s6, 3
  s_add_u32 s14, s14, s50
  s_mul_i32 s14, s14, 7168
  s_and_b32 s50, s3, 1
  s_mul_i32 s50, s50, 3584
  s_add_u32 s14, s14, s50
  s_add_u32 s14, s14, 9748480
  s_mul_i32 s15, s7, 336
  s_mul_i32 s50, s3, 14
  s_add_u32 s15, s15, s50
  s_add_u32 s15, s15, 112
  s_lshl_b32 s15, s15, 10
  s_add_u32 s15, s15, 3670016
  s_mul_i32 s9, s3, 1835008
  s_lshl_b32 s50, s6, 7
  s_add_u32 s9, s9, s50
  s_mov_b32 s8, s9
  s_mul_i32 s11, s7, 336
  s_mul_i32 s50, s3, 28
  s_add_u32 s11, s11, s50
  s_lshl_b32 s11, s11, 10
  s_add_u32 s11, s11, 3670016
  s_mov_b32 s10, s11
  v_lshrrev_b32 v2, 3, v1
  v_mul_u32_u24 v2, 4096, v2
  v_lshrrev_b32 v3, 4, v1
  v_and_b32 v3, 1, v3
  v_lshlrev_b32 v4, 2, v3
  v_and_b32 v5, 7, v1
  v_xor_b32 v4, v4, v5
  v_lshl_add_u32 v2, v4, 4, v2
  v_lshrrev_b32 v4, 1, v1
  v_and_b32 v4, 1, v4
  v_and_b32 v16, 1, v1
  v_lshl_add_u32 v4, v3, 1, v4
  s_lshl_b32 s50, s3, 1
  v_xor_b32 v14, s50, v4
  v_lshrrev_b32 v5, 3, v1
  v_and_b32 v5, 1, v5
  v_lshlrev_b32 v5, 2, v5
  v_xor_b32 v4, v14, v5
  v_lshlrev_b32 v6, 4, v4
  v_lshl_add_u32 v6, v16, 3, v6
  v_lshrrev_b32 v15, 2, v1
  v_and_b32 v15, 3, v15
  v_lshrrev_b32 v5, 5, v1
  v_lshl_add_u32 v4, v5, 3, v15
  v_lshl_add_u32 v6, v4, 7, v6
  v_add_u32 v6, s13, v6
  v_xor_b32 v7, 64, v6
  v_add_u32 v3, 31744, v2
  v_lshrrev_b32 v8, 3, v1
  v_mul_u32_u24 v8, 7168, v8
  v_lshrrev_b32 v9, 4, v1
  v_and_b32 v9, 1, v9
  v_lshlrev_b32 v9, 2, v9
  v_and_b32 v10, 7, v1
  v_xor_b32 v9, v9, v10
  v_lshl_add_u32 v8, v9, 4, v8
  v_lshrrev_b32 v10, 1, v14
  v_and_b32 v10, 1, v10
  v_lshlrev_b32 v10, 2, v10
  v_xor_b32 v10, v10, v15
  v_lshlrev_b32 v10, 4, v10
  v_lshl_add_u32 v10, v14, 7, v10
  v_lshl_add_u32 v10, v5, 10, v10
  v_and_b32 v11, 1, v1
  v_lshl_add_u32 v10, v11, 3, v10
  v_add_u32 v10, s13, v10
  v_xor_b32 v11, 64, v10
  v_xor_b32 v12, 512, v10
  v_xor_b32 v13, 512, v11
  v_lshlrev_b32 v4, 4, v1
  v_add_u32 v5, 172032, v4
  s_mov_b32 s56, s40
  s_and_b32 s57, s41, 0xffff
  s_mov_b32 s58, 7340032
  s_mov_b32 s59, 0x20000
  s_mov_b32 s60, s16
  s_and_b32 s61, s17, 0xffff
  s_mov_b32 s62, 1835008
  s_mov_b32 s63, 0x20000
  s_mov_b32 s64, s44
  s_and_b32 s65, s45, 0xffff
  s_mov_b32 s66, 3670016
  s_mov_b32 s67, 0x20000
  s_add_u32 m0, s13, 0
  s_nop 0
  buffer_load_dwordx4 v2, s[56:59], s8 offen  lds
  buffer_load_dwordx4 v3, s[56:59], s8 offen offset:1024  lds
  s_add_u32 s8, s8, 65536
  s_add_u32 m0, s13, 2048
  s_nop 0
  buffer_load_dwordx4 v2, s[56:59], s8 offen  lds
  buffer_load_dwordx4 v3, s[56:59], s8 offen offset:1024  lds
  s_add_u32 s8, s8, 65536
  s_add_u32 m0, s13, 4096
  s_nop 0
  buffer_load_dwordx4 v2, s[56:59], s8 offen  lds
  buffer_load_dwordx4 v3, s[56:59], s8 offen offset:1024  lds
  s_add_u32 s8, s8, 65536
  s_add_u32 m0, s13, 6144
  s_nop 0
  buffer_load_dwordx4 v2, s[56:59], s8 offen  lds
  buffer_load_dwordx4 v3, s[56:59], s8 offen offset:1024  lds
  s_add_u32 s8, s8, 65536
  v_and_b32 v16, 31, v1
  s_and_b32 s50, s3, 1
  s_lshl_b32 s50, s50, 4
  v_xor_b32 v17, s50, v16
  v_lshrrev_b32 v18, 5, v1
  v_lshlrev_b32 v19, 9, v18
  v_lshl_add_u32 v19, v17, 4, v19
  s_lshr_b32 s72, s3, 1
  s_xor_b32 s50, s72, 0
  s_lshl_b32 s51, s6, 1
  s_add_u32 s51, s51, s50
  s_mul_i32 s51, s51, 28
  s_lshl_b32 s50, s7, 2
  s_add_u32 s51, s51, s50
  s_add_u32 s51, s51, s3
  s_lshl_b32 s51, s51, 10
  s_add_u32 s51, s51, 1835008
  buffer_load_dwordx4 v[160:163], v19, s[52:55], s51 offen sc1
  s_xor_b32 s50, s72, 1
  s_lshl_b32 s51, s6, 1
  s_add_u32 s51, s51, s50
  s_mul_i32 s51, s51, 28
  s_lshl_b32 s50, s7, 2
  s_add_u32 s51, s51, s50
  s_add_u32 s51, s51, s3
  s_lshl_b32 s51, s51, 10
  s_add_u32 s51, s51, 1835008
  buffer_load_dwordx4 v[164:167], v19, s[52:55], s51 offen sc1
  v_mul_u32_u24 v20, 896, v17
  v_lshl_add_u32 v20, v18, 4, v20
  s_xor_b32 s50, s72, 0
  s_lshl_b32 s51, s6, 1
  s_add_u32 s51, s51, s50
  s_mul_i32 s51, s51, 28672
  s_lshl_b32 s50, s7, 7
  s_add_u32 s51, s51, s50
  s_lshl_b32 s50, s3, 5
  s_add_u32 s51, s51, s50
  buffer_load_dwordx4 v[168:171], v20, s[60:63], s51 offen
  s_xor_b32 s50, s72, 1
  s_lshl_b32 s51, s6, 1
  s_add_u32 s51, s51, s50
  s_mul_i32 s51, s51, 28672
  s_lshl_b32 s50, s7, 7
  s_add_u32 s51, s51, s50
  s_lshl_b32 s50, s3, 5
  s_add_u32 s51, s51, s50
  buffer_load_dwordx4 v[172:175], v20, s[60:63], s51 offen
  s_lshl_b32 s50, s6, 6
  v_add_u32 v21, s50, v17
  v_lshlrev_b32 v21, 1, v21
  s_xor_b32 s50, s72, 0
  s_lshl_b32 s50, s50, 6
  v_add_u32 v22, s50, v21
  global_load_ushort v176, v22, s[42:43]
  s_xor_b32 s50, s72, 1
  s_lshl_b32 s50, s50, 6
  v_add_u32 v22, s50, v21
  global_load_ushort v177, v22, s[42:43]
  s_lshl_b32 s50, s7, 6
  s_lshl_b32 s51, s72, 5
  s_add_u32 s50, s50, s51
  v_add_u32 v22, s50, v16
  v_lshlrev_b32 v22, 1, v22
  global_load_ushort v178, v22, s[32:33]
  v_lshlrev_b32 v23, 4, v1
  s_xor_b32 s50, s3, 1
  s_lshl_b32 s51, s50, 2
  s_add_u32 s51, s51, s3
  s_lshl_b32 s51, s51, 12
  s_add_u32 s51, s51, 32768
  v_add_u32 v24, s51, v23
  s_lshl_b32 s51, s3, 2
  s_add_u32 s51, s51, s50
  s_lshl_b32 s51, s51, 12
  s_add_u32 s51, s51, 32768
  v_add_u32 v27, s51, v23
  s_xor_b32 s50, s3, 2
  s_lshl_b32 s51, s50, 2
  s_add_u32 s51, s51, s3
  s_lshl_b32 s51, s51, 12
  s_add_u32 s51, s51, 32768
  v_add_u32 v25, s51, v23
  s_lshl_b32 s51, s3, 2
  s_add_u32 s51, s51, s50
  s_lshl_b32 s51, s51, 12
  s_add_u32 s51, s51, 32768
  v_add_u32 v28, s51, v23
  s_xor_b32 s50, s3, 3
  s_lshl_b32 s51, s50, 2
  s_add_u32 s51, s51, s3
  s_lshl_b32 s51, s51, 12
  s_add_u32 s51, s51, 32768
  v_add_u32 v26, s51, v23
  s_lshl_b32 s51, s3, 2
  s_add_u32 s51, s51, s50
  s_lshl_b32 s51, s51, 12
  s_add_u32 s51, s51, 32768
  v_add_u32 v29, s51, v23
  s_lshl_b32 s74, s7, 5
  v_min_u32 v241, 27, v1
  v_add_u32 v241, s74, v241
  v_lshlrev_b32 v241, 6, v241
  s_cmp_eq_u32 s3, 0
  s_mov_b32 s51, 2147483648
  s_cselect_b32 s50, 13680640, s51
  v_add_u32 v241, s50, v241
  buffer_load_dword v248, v241, s[52:55], 0 offen sc1
  s_waitcnt vmcnt(0)
  s_cmp_lg_u32 s3, 0
  s_cbranch_scc1 L_pco28
  s_mov_b32 s50, 0
L_pc27:
  v_xor_b32 v248, s75, v248
  v_cmp_ne_u32 vcc, 0, v248
  s_add_u32 s50, s50, 1
  s_cmp_ge_u32 s50, 131072
  s_cbranch_scc1 L_pco28
  s_cbranch_vccz L_pco28
  s_sleep 4
  buffer_load_dword v248, v241, s[52:55], 0 offen sc1
  s_waitcnt vmcnt(0)
  s_branch L_pc27
L_pco28:
  s_barrier
  buffer_load_dwordx4 v[128:131], v4, s[52:55], s10 offen sc1
  buffer_load_dwordx4 v[132:135], v5, s[52:55], s10 offen sc1
  s_add_u32 s10, s10, 1024
  buffer_load_dwordx4 v[136:139], v4, s[52:55], s10 offen sc1
  buffer_load_dwordx4 v[140:143], v5, s[52:55], s10 offen sc1
  s_add_u32 s10, s10, 1024
  buffer_load_dwordx4 v[144:147], v4, s[52:55], s10 offen sc1
  buffer_load_dwordx4 v[148:151], v5, s[52:55], s10 offen sc1
  s_add_u32 s10, s10, 1024
  buffer_load_dwordx4 v[152:155], v4, s[52:55], s10 offen sc1
  buffer_load_dwordx4 v[156:159], v5, s[52:55], s10 offen sc1
  s_add_u32 s10, s10, 1024
  s_waitcnt vmcnt(6)
  ds_read_b64_tr_b16 v[32:33], v6 offset:0
  ds_read_b64_tr_b16 v[34:35], v6 offset:512
  ds_read_b64_tr_b16 v[36:37], v7 offset:0
  ds_read_b64_tr_b16 v[38:39], v7 offset:512
  s_waitcnt vmcnt(4) lgkmcnt(0)
  ds_read_b64_tr_b16 v[40:41], v6 offset:2048
  ds_read_b64_tr_b16 v[42:43], v6 offset:2560
  ds_read_b64_tr_b16 v[44:45], v7 offset:2048
  ds_read_b64_tr_b16 v[46:47], v7 offset:2560
  s_add_u32 m0, s13, 0
  s_nop 0
  buffer_load_dwordx4 v2, s[56:59], s8 offen  lds
  buffer_load_dwordx4 v3, s[56:59], s8 offen offset:1024  lds
  s_add_u32 s8, s8, 65536
  v_mfma_f32_32x32x16_bf16 v[64:79], v[32:35], v[128:131], 0
  v_mfma_f32_32x32x16_bf16 v[80:95], v[32:35], v[132:135], 0
  v_mfma_f32_32x32x16_bf16 v[96:111], v[36:39], v[128:131], 0
  v_mfma_f32_32x32x16_bf16 v[112:127], v[36:39], v[132:135], 0
  buffer_load_dwordx4 v[128:131], v4, s[52:55], s10 offen sc1
  buffer_load_dwordx4 v[132:135], v5, s[52:55], s10 offen sc1
  s_add_u32 s10, s10, 1024
  s_waitcnt vmcnt(6) lgkmcnt(0)
  ds_read_b64_tr_b16 v[32:33], v6 offset:4096
  ds_read_b64_tr_b16 v[34:35], v6 offset:4608
  ds_read_b64_tr_b16 v[36:37], v7 offset:4096
  ds_read_b64_tr_b16 v[38:39], v7 offset:4608
  s_add_u32 m0, s13, 2048
  s_nop 0
  buffer_load_dwordx4 v2, s[56:59], s8 offen  lds
  buffer_load_dwordx4 v3, s[56:59], s8 offen offset:1024  lds
  s_add_u32 s8, s8, 65536
  v_mfma_f32_32x32x16_bf16 v[64:79], v[40:43], v[136:139], v[64:79]
  v_mfma_f32_32x32x16_bf16 v[80:95], v[40:43], v[140:143], v[80:95]
  v_mfma_f32_32x32x16_bf16 v[96:111], v[44:47], v[136:139], v[96:111]
  v_mfma_f32_32x32x16_bf16 v[112:127], v[44:47], v[140:143], v[112:127]
  buffer_load_dwordx4 v[136:139], v4, s[52:55], s10 offen sc1
  buffer_load_dwordx4 v[140:143], v5, s[52:55], s10 offen sc1
  s_add_u32 s10, s10, 1024
  s_waitcnt vmcnt(8) lgkmcnt(0)
  ds_read_b64_tr_b16 v[40:41], v6 offset:6144
  ds_read_b64_tr_b16 v[42:43], v6 offset:6656
  ds_read_b64_tr_b16 v[44:45], v7 offset:6144
  ds_read_b64_tr_b16 v[46:47], v7 offset:6656
  s_add_u32 m0, s13, 4096
  s_nop 0
  buffer_load_dwordx4 v2, s[56:59], s8 offen  lds
  buffer_load_dwordx4 v3, s[56:59], s8 offen offset:1024  lds
  s_add_u32 s8, s8, 65536
  v_mfma_f32_32x32x16_bf16 v[64:79], v[32:35], v[144:147], v[64:79]
  v_mfma_f32_32x32x16_bf16 v[80:95], v[32:35], v[148:151], v[80:95]
  v_mfma_f32_32x32x16_bf16 v[96:111], v[36:39], v[144:147], v[96:111]
  v_mfma_f32_32x32x16_bf16 v[112:127], v[36:39], v[148:151], v[112:127]
  buffer_load_dwordx4 v[144:147], v4, s[52:55], s10 offen sc1
  buffer_load_dwordx4 v[148:151], v5, s[52:55], s10 offen sc1
  s_add_u32 s10, s10, 1024
  s_and_b32 s50, s3, 1
  s_lshl_b32 s50, s50, 4
  v_lshlrev_b32 v20, 3, v18
  v_add_u32 v20, s50, v20
  v_sub_u32 v20, v16, v20
  v_and_b32 v21, 1, v20
  v_lshlrev_b32 v21, 4, v21
  v_lshlrev_b32 v22, v21, v178
  v_mov_b32 v19, 0x3f80
  v_lshlrev_b32 v19, v21, v19
  v_lshrrev_b32 v20, 1, v20
  v_cmp_eq_u32 vcc, 0, v20
  s_nop 1
  v_cndmask_b32 v180, 0, v22, vcc
  v_cndmask_b32 v184, 0, v19, vcc
  v_cmp_eq_u32 vcc, 1, v20
  s_nop 1
  v_cndmask_b32 v181, 0, v22, vcc
  v_cndmask_b32 v185, 0, v19, vcc
  v_cmp_eq_u32 vcc, 2, v20
  s_nop 1
  v_cndmask_b32 v182, 0, v22, vcc
  v_cndmask_b32 v186, 0, v19, vcc
  v_cmp_eq_u32 vcc, 3, v20
  s_nop 1
  v_cndmask_b32 v183, 0, v22, vcc
  v_cndmask_b32 v187, 0, v19, vcc
  v_cmp_gt_u32 vcc, 32, v1
  s_cmp_eq_u32 s3, 0
  s_cselect_b64 s[50:51], -1, 0
  s_and_b64 vcc, vcc, s[50:51]
  s_nop 1
  v_cndmask_b32 v188, 0, v176, vcc
  v_cndmask_b32 v192, 0, v177, vcc
  v_mov_b32 v189, 0
  v_mov_b32 v193, 0
  v_mov_b32 v190, 0
  v_mov_b32 v194, 0
  v_mov_b32 v191, 0
  v_mov_b32 v195, 0
  v_mov_b32 v196, 0x3f80
  v_mov_b32 v197, 0
  v_mov_b32 v198, 0
  v_mov_b32 v199, 0
  s_nop 1
  s_cmp_ge_u32 s3, 2
  s_cbranch_scc1 L_ext29
  v_mfma_f32_32x32x16_bf16 v[64:79], v[160:163], v[180:183], v[64:79]
  v_mfma_f32_32x32x16_bf16 v[64:79], v[168:171], v[184:187], v[64:79]
  v_mfma_f32_32x32x16_bf16 v[96:111], v[164:167], v[180:183], v[96:111]
  v_mfma_f32_32x32x16_bf16 v[96:111], v[172:175], v[184:187], v[96:111]
  s_branch L_ext30
L_ext29:
  v_mfma_f32_32x32x16_bf16 v[80:95], v[160:163], v[180:183], v[80:95]
  v_mfma_f32_32x32x16_bf16 v[80:95], v[168:171], v[184:187], v[80:95]
  v_mfma_f32_32x32x16_bf16 v[112:127], v[164:167], v[180:183], v[112:127]
  v_mfma_f32_32x32x16_bf16 v[112:127], v[172:175], v[184:187], v[112:127]
L_ext30:
  v_mfma_f32_32x32x16_bf16 v[64:79], v[188:191], v[196:199], v[64:79]
  v_mfma_f32_32x32x16_bf16 v[80:95], v[188:191], v[196:199], v[80:95]
  v_mfma_f32_32x32x16_bf16 v[96:111], v[192:195], v[196:199], v[96:111]
  v_mfma_f32_32x32x16_bf16 v[112:127], v[192:195], v[196:199], v[112:127]
  s_waitcnt vmcnt(8) lgkmcnt(0)
  ds_read_b64_tr_b16 v[32:33], v6 offset:0
  ds_read_b64_tr_b16 v[34:35], v6 offset:512
  ds_read_b64_tr_b16 v[36:37], v7 offset:0
  ds_read_b64_tr_b16 v[38:39], v7 offset:512
  s_add_u32 m0, s13, 6144
  s_nop 0
  buffer_load_dwordx4 v2, s[56:59], s8 offen  lds
  buffer_load_dwordx4 v3, s[56:59], s8 offen offset:1024  lds
  s_add_u32 s8, s8, 65536
  v_mfma_f32_32x32x16_bf16 v[64:79], v[40:43], v[152:155], v[64:79]
  v_mfma_f32_32x32x16_bf16 v[80:95], v[40:43], v[156:159], v[80:95]
  v_mfma_f32_32x32x16_bf16 v[96:111], v[44:47], v[152:155], v[96:111]
  v_mfma_f32_32x32x16_bf16 v[112:127], v[44:47], v[156:159], v[112:127]
  buffer_load_dwordx4 v[152:155], v4, s[52:55], s10 offen sc1
  buffer_load_dwordx4 v[156:159], v5, s[52:55], s10 offen sc1
  s_add_u32 s10, s10, 1024
  s_waitcnt vmcnt(8) lgkmcnt(0)
  ds_read_b64_tr_b16 v[40:41], v6 offset:2048
  ds_read_b64_tr_b16 v[42:43], v6 offset:2560
  ds_read_b64_tr_b16 v[44:45], v7 offset:2048
  ds_read_b64_tr_b16 v[46:47], v7 offset:2560
  s_add_u32 m0, s13, 0
  s_nop 0
  buffer_load_dwordx4 v2, s[56:59], s8 offen  lds
  buffer_load_dwordx4 v3, s[56:59], s8 offen offset:1024  lds
  s_add_u32 s8, s8, 65536
  v_mfma_f32_32x32x16_bf16 v[64:79], v[32:35], v[128:131], v[64:79]
  v_mfma_f32_32x32x16_bf16 v[80:95], v[32:35], v[132:135], v[80:95]
  v_mfma_f32_32x32x16_bf16 v[96:111], v[36:39], v[128:131], v[96:111]
  v_mfma_f32_32x32x16_bf16 v[112:127], v[36:39], v[132:135], v[112:127]
  buffer_load_dwordx4 v[128:131], v4, s[52:55], s10 offen sc1
  buffer_load_dwordx4 v[132:135], v5, s[52:55], s10 offen sc1
  s_add_u32 s10, s10, 1024
  s_waitcnt vmcnt(8) lgkmcnt(0)
  ds_read_b64_tr_b16 v[32:33], v6 offset:4096
  ds_read_b64_tr_b16 v[34:35], v6 offset:4608
  ds_read_b64_tr_b16 v[36:37], v7 offset:4096
  ds_read_b64_tr_b16 v[38:39], v7 offset:4608
  s_add_u32 m0, s13, 2048
  s_nop 0
  buffer_load_dwordx4 v2, s[56:59], s8 offen  lds
  buffer_load_dwordx4 v3, s[56:59], s8 offen offset:1024  lds
  s_add_u32 s8, s8, 65536
  v_mfma_f32_32x32x16_bf16 v[64:79], v[40:43], v[136:139], v[64:79]
  v_mfma_f32_32x32x16_bf16 v[80:95], v[40:43], v[140:143], v[80:95]
  v_mfma_f32_32x32x16_bf16 v[96:111], v[44:47], v[136:139], v[96:111]
  v_mfma_f32_32x32x16_bf16 v[112:127], v[44:47], v[140:143], v[112:127]
  buffer_load_dwordx4 v[136:139], v4, s[52:55], s10 offen sc1
  buffer_load_dwordx4 v[140:143], v5, s[52:55], s10 offen sc1
  s_add_u32 s10, s10, 1024
  s_waitcnt vmcnt(8) lgkmcnt(0)
  ds_read_b64_tr_b16 v[40:41], v6 offset:6144
  ds_read_b64_tr_b16 v[42:43], v6 offset:6656
  ds_read_b64_tr_b16 v[44:45], v7 offset:6144
  ds_read_b64_tr_b16 v[46:47], v7 offset:6656
  s_add_u32 m0, s13, 4096
  s_nop 0
  buffer_load_dwordx4 v2, s[56:59], s8 offen  lds
  buffer_load_dwordx4 v3, s[56:59], s8 offen offset:1024  lds
  s_add_u32 s8, s8, 65536
  v_mfma_f32_32x32x16_bf16 v[64:79], v[32:35], v[144:147], v[64:79]
  v_mfma_f32_32x32x16_bf16 v[80:95], v[32:35], v[148:151], v[80:95]
  v_mfma_f32_32x32x16_bf16 v[96:111], v[36:39], v[144:147], v[96:111]
  v_mfma_f32_32x32x16_bf16 v[112:127], v[36:39], v[148:151], v[112:127]
  buffer_load_dwordx4 v[144:147], v4, s[52:55], s10 offen sc1
  buffer_load_dwordx4 v[148:151], v5, s[52:55], s10 offen sc1
  s_add_u32 s10, s10, 1024
  s_waitcnt vmcnt(8) lgkmcnt(0)
  ds_read_b64_tr_b16 v[32:33], v6 offset:0
  ds_read_b64_tr_b16 v[34:35], v6 offset:512
  ds_read_b64_tr_b16 v[36:37], v7 offset:0
  ds_read_b64_tr_b16 v[38:39], v7 offset:512
  s_add_u32 m0, s13, 6144
  s_nop 0
  buffer_load_dwordx4 v2, s[56:59], s8 offen  lds
  buffer_load_dwordx4 v3, s[56:59], s8 offen offset:1024  lds
  s_add_u32 s8, s8, 65536
  v_mfma_f32_32x32x16_bf16 v[64:79], v[40:43], v[152:155], v[64:79]
  v_mfma_f32_32x32x16_bf16 v[80:95], v[40:43], v[156:159], v[80:95]
  v_mfma_f32_32x32x16_bf16 v[96:111], v[44:47], v[152:155], v[96:111]
  v_mfma_f32_32x32x16_bf16 v[112:127], v[44:47], v[156:159], v[112:127]
  buffer_load_dwordx4 v[152:155], v4, s[52:55], s10 offen sc1
  buffer_load_dwordx4 v[156:159], v5, s[52:55], s10 offen sc1
  s_add_u32 s10, s10, 1024
  s_waitcnt vmcnt(8) lgkmcnt(0)
  ds_read_b64_tr_b16 v[40:41], v6 offset:2048
  ds_read_b64_tr_b16 v[42:43], v6 offset:2560
  ds_read_b64_tr_b16 v[44:45], v7 offset:2048
  ds_read_b64_tr_b16 v[46:47], v7 offset:2560
  s_add_u32 m0, s13, 0
  s_nop 0
  buffer_load_dwordx4 v2, s[56:59], s8 offen  lds
  buffer_load_dwordx4 v3, s[56:59], s8 offen offset:1024  lds
  s_add_u32 s8, s8, 65536
  v_mfma_f32_32x32x16_bf16 v[64:79], v[32:35], v[128:131], v[64:79]
  v_mfma_f32_32x32x16_bf16 v[80:95], v[32:35], v[132:135], v[80:95]
  v_mfma_f32_32x32x16_bf16 v[96:111], v[36:39], v[128:131], v[96:111]
  v_mfma_f32_32x32x16_bf16 v[112:127], v[36:39], v[132:135], v[112:127]
  buffer_load_dwordx4 v[128:131], v4, s[52:55], s10 offen sc1
  buffer_load_dwordx4 v[132:135], v5, s[52:55], s10 offen sc1
  s_add_u32 s10, s10, 1024
  s_waitcnt vmcnt(8) lgkmcnt(0)
  ds_read_b64_tr_b16 v[32:33], v6 offset:4096
  ds_read_b64_tr_b16 v[34:35], v6 offset:4608
  ds_read_b64_tr_b16 v[36:37], v7 offset:4096
  ds_read_b64_tr_b16 v[38:39], v7 offset:4608
  s_add_u32 m0, s13, 2048
  s_nop 0
  buffer_load_dwordx4 v2, s[56:59], s8 offen  lds
  buffer_load_dwordx4 v3, s[56:59], s8 offen offset:1024  lds
  s_add_u32 s8, s8, 65536
  v_mfma_f32_32x32x16_bf16 v[64:79], v[40:43], v[136:139], v[64:79]
  v_mfma_f32_32x32x16_bf16 v[80:95], v[40:43], v[140:143], v[80:95]
  v_mfma_f32_32x32x16_bf16 v[96:111], v[44:47], v[136:139], v[96:111]
  v_mfma_f32_32x32x16_bf16 v[112:127], v[44:47], v[140:143], v[112:127]
  buffer_load_dwordx4 v[136:139], v4, s[52:55], s10 offen sc1
  buffer_load_dwordx4 v[140:143], v5, s[52:55], s10 offen sc1
  s_add_u32 s10, s10, 1024
  s_waitcnt vmcnt(8) lgkmcnt(0)
  ds_read_b64_tr_b16 v[40:41], v6 offset:6144
  ds_read_b64_tr_b16 v[42:43], v6 offset:6656
  ds_read_b64_tr_b16 v[44:45], v7 offset:6144
  ds_read_b64_tr_b16 v[46:47], v7 offset:6656
  s_add_u32 m0, s13, 4096
  s_nop 0
  buffer_load_dwordx4 v2, s[56:59], s8 offen  lds
  buffer_load_dwordx4 v3, s[56:59], s8 offen offset:1024  lds
  s_add_u32 s8, s8, 65536
  v_mfma_f32_32x32x16_bf16 v[64:79], v[32:35], v[144:147], v[64:79]
  v_mfma_f32_32x32x16_bf16 v[80:95], v[32:35], v[148:151], v[80:95]
  v_mfma_f32_32x32x16_bf16 v[96:111], v[36:39], v[144:147], v[96:111]
  v_mfma_f32_32x32x16_bf16 v[112:127], v[36:39], v[148:151], v[112:127]
  buffer_load_dwordx4 v[144:147], v4, s[52:55], s10 offen sc1
  buffer_load_dwordx4 v[148:151], v5, s[52:55], s10 offen sc1
  s_add_u32 s10, s10, 1024
  s_waitcnt vmcnt(8) lgkmcnt(0)
  ds_read_b64_tr_b16 v[32:33], v6 offset:0
  ds_read_b64_tr_b16 v[34:35], v6 offset:512
  ds_read_b64_tr_b16 v[36:37], v7 offset:0
  ds_read_b64_tr_b16 v[38:39], v7 offset:512
  s_add_u32 m0, s13, 6144
  s_nop 0
  buffer_load_dwordx4 v2, s[56:59], s8 offen  lds
  buffer_load_dwordx4 v3, s[56:59], s8 offen offset:1024  lds
  s_add_u32 s8, s8, 65536
  v_mfma_f32_32x32x16_bf16 v[64:79], v[40:43], v[152:155], v[64:79]
  v_mfma_f32_32x32x16_bf16 v[80:95], v[40:43], v[156:159], v[80:95]
  v_mfma_f32_32x32x16_bf16 v[96:111], v[44:47], v[152:155], v[96:111]
  v_mfma_f32_32x32x16_bf16 v[112:127], v[44:47], v[156:159], v[112:127]
  buffer_load_dwordx4 v[152:155], v4, s[52:55], s10 offen sc1
  buffer_load_dwordx4 v[156:159], v5, s[52:55], s10 offen sc1
  s_add_u32 s10, s10, 1024
  s_waitcnt vmcnt(8) lgkmcnt(0)
  ds_read_b64_tr_b16 v[40:41], v6 offset:2048
  ds_read_b64_tr_b16 v[42:43], v6 offset:2560
  ds_read_b64_tr_b16 v[44:45], v7 offset:2048
  ds_read_b64_tr_b16 v[46:47], v7 offset:2560
  s_add_u32 m0, s13, 0
  s_nop 0
  buffer_load_dwordx4 v2, s[56:59], s8 offen  lds
  buffer_load_dwordx4 v3, s[56:59], s8 offen offset:1024  lds
  s_add_u32 s8, s8, 65536
  v_mfma_f32_32x32x16_bf16 v[64:79], v[32:35], v[128:131], v[64:79]
  v_mfma_f32_32x32x16_bf16 v[80:95], v[32:35], v[132:135], v[80:95]
  v_mfma_f32_32x32x16_bf16 v[96:111], v[36:39], v[128:131], v[96:111]
  v_mfma_f32_32x32x16_bf16 v[112:127], v[36:39], v[132:135], v[112:127]
  buffer_load_dwordx4 v[128:131], v4, s[52:55], s10 offen sc1
  buffer_load_dwordx4 v[132:135], v5, s[52:55], s10 offen sc1
  s_add_u32 s10, s10, 1024
  s_waitcnt vmcnt(8) lgkmcnt(0)
  ds_read_b64_tr_b16 v[32:33], v6 offset:4096
  ds_read_b64_tr_b16 v[34:35], v6 offset:4608
  ds_read_b64_tr_b16 v[36:37], v7 offset:4096
  ds_read_b64_tr_b16 v[38:39], v7 offset:4608
  s_add_u32 m0, s13, 2048
  s_nop 0
  buffer_load_dwordx4 v2, s[56:59], s8 offen  lds
  buffer_load_dwordx4 v3, s[56:59], s8 offen offset:1024  lds
  s_add_u32 s8, s8, 65536
  v_mfma_f32_32x32x16_bf16 v[64:79], v[40:43], v[136:139], v[64:79]
  v_mfma_f32_32x32x16_bf16 v[80:95], v[40:43], v[140:143], v[80:95]
  v_mfma_f32_32x32x16_bf16 v[96:111], v[44:47], v[136:139], v[96:111]
  v_mfma_f32_32x32x16_bf16 v[112:127], v[44:47], v[140:143], v[112:127]
  buffer_load_dwordx4 v[136:139], v4, s[52:55], s10 offen sc1
  buffer_load_dwordx4 v[140:143], v5, s[52:55], s10 offen sc1
  s_add_u32 s10, s10, 1024
  s_waitcnt vmcnt(8) lgkmcnt(0)
  ds_read_b64_tr_b16 v[40:41], v6 offset:6144
  ds_read_b64_tr_b16 v[42:43], v6 offset:6656
  ds_read_b64_tr_b16 v[44:45], v7 offset:6144
  ds_read_b64_tr_b16 v[46:47], v7 offset:6656
  s_add_u32 m0, s13, 4096
  s_nop 0
  buffer_load_dwordx4 v2, s[56:59], s8 offen  lds
  buffer_load_dwordx4 v3, s[56:59], s8 offen offset:1024  lds
  s_add_u32 s8, s8, 65536
  v_mfma_f32_32x32x16_bf16 v[64:79], v[32:35], v[144:147], v[64:79]
  v_mfma_f32_32x32x16_bf16 v[80:95], v[32:35], v[148:151], v[80:95]
  v_mfma_f32_32x32x16_bf16 v[96:111], v[36:39], v[144:147], v[96:111]
  v_mfma_f32_32x32x16_bf16 v[112:127], v[36:39], v[148:151], v[112:127]
  buffer_load_dwordx4 v[144:147], v4, s[52:55], s10 offen sc1
  buffer_load_dwordx4 v[148:151], v5, s[52:55], s10 offen sc1
  s_add_u32 s10, s10, 1024
  s_waitcnt vmcnt(8) lgkmcnt(0)
  ds_read_b64_tr_b16 v[32:33], v6 offset:0
  ds_read_b64_tr_b16 v[34:35], v6 offset:512
  ds_read_b64_tr_b16 v[36:37], v7 offset:0
  ds_read_b64_tr_b16 v[38:39], v7 offset:512
  s_add_u32 m0, s13, 6144
  s_nop 0
  buffer_load_dwordx4 v2, s[56:59], s8 offen  lds
  buffer_load_dwordx4 v3, s[56:59], s8 offen offset:1024  lds
  s_add_u32 s8, s8, 65536
  v_mfma_f32_32x32x16_bf16 v[64:79], v[40:43], v[152:155], v[64:79]
  v_mfma_f32_32x32x16_bf16 v[80:95], v[40:43], v[156:159], v[80:95]
  v_mfma_f32_32x32x16_bf16 v[96:111], v[44:47], v[152:155], v[96:111]
  v_mfma_f32_32x32x16_bf16 v[112:127], v[44:47], v[156:159], v[112:127]
  buffer_load_dwordx4 v[152:155], v4, s[52:55], s10 offen sc1
  buffer_load_dwordx4 v[156:159], v5, s[52:55], s10 offen sc1
  s_add_u32 s10, s10, 1024
  s_waitcnt vmcnt(8) lgkmcnt(0)
  ds_read_b64_tr_b16 v[40:41], v6 offset:2048
  ds_read_b64_tr_b16 v[42:43], v6 offset:2560
  ds_read_b64_tr_b16 v[44:45], v7 offset:2048
  ds_read_b64_tr_b16 v[46:47], v7 offset:2560
  s_add_u32 m0, s13, 0
  s_nop 0
  buffer_load_dwordx4 v2, s[56:59], s8 offen  lds
  buffer_load_dwordx4 v3, s[56:59], s8 offen offset:1024  lds
  s_add_u32 s8, s8, 65536
  v_mfma_f32_32x32x16_bf16 v[64:79], v[32:35], v[128:131], v[64:79]
  v_mfma_f32_32x32x16_bf16 v[80:95], v[32:35], v[132:135], v[80:95]
  v_mfma_f32_32x32x16_bf16 v[96:111], v[36:39], v[128:131], v[96:111]
  v_mfma_f32_32x32x16_bf16 v[112:127], v[36:39], v[132:135], v[112:127]
  buffer_load_dwordx4 v[128:131], v4, s[52:55], s10 offen sc1
  buffer_load_dwordx4 v[132:135], v5, s[52:55], s10 offen sc1
  s_add_u32 s10, s10, 1024
  s_waitcnt vmcnt(8) lgkmcnt(0)
  ds_read_b64_tr_b16 v[32:33], v6 offset:4096
  ds_read_b64_tr_b16 v[34:35], v6 offset:4608
  ds_read_b64_tr_b16 v[36:37], v7 offset:4096
  ds_read_b64_tr_b16 v[38:39], v7 offset:4608
  s_add_u32 m0, s13, 2048
  s_nop 0
  buffer_load_dwordx4 v2, s[56:59], s8 offen  lds
  buffer_load_dwordx4 v3, s[56:59], s8 offen offset:1024  lds
  s_add_u32 s8, s8, 65536
  v_mfma_f32_32x32x16_bf16 v[64:79], v[40:43], v[136:139], v[64:79]
  v_mfma_f32_32x32x16_bf16 v[80:95], v[40:43], v[140:143], v[80:95]
  v_mfma_f32_32x32x16_bf16 v[96:111], v[44:47], v[136:139], v[96:111]
  v_mfma_f32_32x32x16_bf16 v[112:127], v[44:47], v[140:143], v[112:127]
  buffer_load_dwordx4 v[136:139], v4, s[52:55], s10 offen sc1
  buffer_load_dwordx4 v[140:143], v5, s[52:55], s10 offen sc1
  s_add_u32 s10, s10, 1024
  s_waitcnt vmcnt(8) lgkmcnt(0)
  ds_read_b64_tr_b16 v[40:41], v6 offset:6144
  ds_read_b64_tr_b16 v[42:43], v6 offset:6656
  ds_read_b64_tr_b16 v[44:45], v7 offset:6144
  ds_read_b64_tr_b16 v[46:47], v7 offset:6656
  s_add_u32 m0, s13, 4096
  s_nop 0
  buffer_load_dwordx4 v2, s[56:59], s8 offen  lds
  buffer_load_dwordx4 v3, s[56:59], s8 offen offset:1024  lds
  s_add_u32 s8, s8, 65536
  v_mfma_f32_32x32x16_bf16 v[64:79], v[32:35], v[144:147], v[64:79]
  v_mfma_f32_32x32x16_bf16 v[80:95], v[32:35], v[148:151], v[80:95]
  v_mfma_f32_32x32x16_bf16 v[96:111], v[36:39], v[144:147], v[96:111]
  v_mfma_f32_32x32x16_bf16 v[112:127], v[36:39], v[148:151], v[112:127]
  buffer_load_dwordx4 v[144:147], v4, s[52:55], s10 offen sc1
  buffer_load_dwordx4 v[148:151], v5, s[52:55], s10 offen sc1
  s_add_u32 s10, s10, 1024
  s_lshr_b32 s74, s6, 2
  s_lshl_b32 s74, s74, 4
  v_min_u32 v242, 6, v1
  v_add_u32 v242, s74, v242
  v_lshlrev_b32 v242, 6, v242
  s_cmp_eq_u32 s3, 0
  s_mov_b32 s51, 2147483648
  s_cselect_b32 s50, 13694976, s51
  v_add_u32 v242, s50, v242
  buffer_load_dword v249, v242, s[52:55], 0 offen sc1
  s_waitcnt vmcnt(9) lgkmcnt(0)
  ds_read_b64_tr_b16 v[32:33], v6 offset:0
  ds_read_b64_tr_b16 v[34:35], v6 offset:512
  ds_read_b64_tr_b16 v[36:37], v7 offset:0
  ds_read_b64_tr_b16 v[38:39], v7 offset:512
  s_add_u32 m0, s13, 6144
  s_nop 0
  buffer_load_dwordx4 v2, s[56:59], s8 offen  lds
  buffer_load_dwordx4 v3, s[56:59], s8 offen offset:1024  lds
  s_add_u32 s8, s8, 65536
  v_mfma_f32_32x32x16_bf16 v[64:79], v[40:43], v[152:155], v[64:79]
  v_mfma_f32_32x32x16_bf16 v[80:95], v[40:43], v[156:159], v[80:95]
  v_mfma_f32_32x32x16_bf16 v[96:111], v[44:47], v[152:155], v[96:111]
  v_mfma_f32_32x32x16_bf16 v[112:127], v[44:47], v[156:159], v[112:127]
  buffer_load_dwordx4 v[152:155], v4, s[52:55], s10 offen sc1
  buffer_load_dwordx4 v[156:159], v5, s[52:55], s10 offen sc1
  s_add_u32 s10, s10, 1024
  s_waitcnt vmcnt(9) lgkmcnt(0)
  ds_read_b64_tr_b16 v[40:41], v6 offset:2048
  ds_read_b64_tr_b16 v[42:43], v6 offset:2560
  ds_read_b64_tr_b16 v[44:45], v7 offset:2048
  ds_read_b64_tr_b16 v[46:47], v7 offset:2560
  s_add_u32 m0, s13, 0
  s_nop 0
  buffer_load_dwordx4 v2, s[56:59], s8 offen  lds
  buffer_load_dwordx4 v3, s[56:59], s8 offen offset:1024  lds
  s_add_u32 s8, s8, 65536
  v_mfma_f32_32x32x16_bf16 v[64:79], v[32:35], v[128:131], v[64:79]
  v_mfma_f32_32x32x16_bf16 v[80:95], v[32:35], v[132:135], v[80:95]
  v_mfma_f32_32x32x16_bf16 v[96:111], v[36:39], v[128:131], v[96:111]
  v_mfma_f32_32x32x16_bf16 v[112:127], v[36:39], v[132:135], v[112:127]
  buffer_load_dwordx4 v[128:131], v4, s[52:55], s10 offen sc1
  buffer_load_dwordx4 v[132:135], v5, s[52:55], s10 offen sc1
  s_add_u32 s10, s10, 1024
  s_waitcnt vmcnt(9) lgkmcnt(0)
  ds_read_b64_tr_b16 v[32:33], v6 offset:4096
  ds_read_b64_tr_b16 v[34:35], v6 offset:4608
  ds_read_b64_tr_b16 v[36:37], v7 offset:4096
  ds_read_b64_tr_b16 v[38:39], v7 offset:4608
  s_add_u32 m0, s13, 2048
  s_nop 0
  buffer_load_dwordx4 v2, s[56:59], s8 offen  lds
  buffer_load_dwordx4 v3, s[56:59], s8 offen offset:1024  lds
  s_add_u32 s8, s8, 65536
  v_mfma_f32_32x32x16_bf16 v[64:79], v[40:43], v[136:139], v[64:79]
  v_mfma_f32_32x32x16_bf16 v[80:95], v[40:43], v[140:143], v[80:95]
  v_mfma_f32_32x32x16_bf16 v[96:111], v[44:47], v[136:139], v[96:111]
  v_mfma_f32_32x32x16_bf16 v[112:127], v[44:47], v[140:143], v[112:127]
  buffer_load_dwordx4 v[136:139], v4, s[52:55], s10 offen sc1
  buffer_load_dwordx4 v[140:143], v5, s[52:55], s10 offen sc1
  s_add_u32 s10, s10, 1024
  s_waitcnt vmcnt(8) lgkmcnt(0)
  ds_read_b64_tr_b16 v[40:41], v6 offset:6144
  ds_read_b64_tr_b16 v[42:43], v6 offset:6656
  ds_read_b64_tr_b16 v[44:45], v7 offset:6144
  ds_read_b64_tr_b16 v[46:47], v7 offset:6656
  s_add_u32 m0, s13, 4096
  s_nop 0
  buffer_load_dwordx4 v2, s[56:59], s8 offen  lds
  buffer_load_dwordx4 v3, s[56:59], s8 offen offset:1024  lds
  s_add_u32 s8, s8, 65536
  v_mfma_f32_32x32x16_bf16 v[64:79], v[32:35], v[144:147], v[64:79]
  v_mfma_f32_32x32x16_bf16 v[80:95], v[32:35], v[148:151], v[80:95]
  v_mfma_f32_32x32x16_bf16 v[96:111], v[36:39], v[144:147], v[96:111]
  v_mfma_f32_32x32x16_bf16 v[112:127], v[36:39], v[148:151], v[112:127]
  buffer_load_dwordx4 v[144:147], v4, s[52:55], s10 offen sc1
  buffer_load_dwordx4 v[148:151], v5, s[52:55], s10 offen sc1
  s_add_u32 s10, s10, 1024
  s_waitcnt vmcnt(8) lgkmcnt(0)
  ds_read_b64_tr_b16 v[32:33], v6 offset:0
  ds_read_b64_tr_b16 v[34:35], v6 offset:512
  ds_read_b64_tr_b16 v[36:37], v7 offset:0
  ds_read_b64_tr_b16 v[38:39], v7 offset:512
  s_add_u32 m0, s13, 6144
  s_nop 0
  buffer_load_dwordx4 v2, s[56:59], s8 offen  lds
  buffer_load_dwordx4 v3, s[56:59], s8 offen offset:1024  lds
  s_add_u32 s8, s8, 65536
  v_mfma_f32_32x32x16_bf16 v[64:79], v[40:43], v[152:155], v[64:79]
  v_mfma_f32_32x32x16_bf16 v[80:95], v[40:43], v[156:159], v[80:95]
  v_mfma_f32_32x32x16_bf16 v[96:111], v[44:47], v[152:155], v[96:111]
  v_mfma_f32_32x32x16_bf16 v[112:127], v[44:47], v[156:159], v[112:127]
  buffer_load_dwordx4 v[152:155], v4, s[52:55], s10 offen sc1
  buffer_load_dwordx4 v[156:159], v5, s[52:55], s10 offen sc1
  s_add_u32 s10, s10, 1024
  s_waitcnt vmcnt(8) lgkmcnt(0)
  ds_read_b64_tr_b16 v[40:41], v6 offset:2048
  ds_read_b64_tr_b16 v[42:43], v6 offset:2560
  ds_read_b64_tr_b16 v[44:45], v7 offset:2048
  ds_read_b64_tr_b16 v[46:47], v7 offset:2560
  s_cmp_lg_u32 s3, 0
  s_cbranch_scc1 L_pco32
  s_mov_b32 s50, 0
L_pc31:
  v_xor_b32 v249, s75, v249
  v_cmp_ne_u32 vcc, 0, v249
  s_add_u32 s50, s50, 1
  s_cmp_ge_u32 s50, 131072
  s_cbranch_scc1 L_pco32
  s_cbranch_vccz L_pco32
  s_sleep 4
  buffer_load_dword v249, v242, s[52:55], 0 offen sc1
  s_waitcnt vmcnt(0)
  s_branch L_pc31
L_pco32:
  s_barrier
  s_add_u32 m0, s13, 0
  s_nop 0
  buffer_load_dwordx4 v8, s[52:55], s14 offen sc1 lds
  s_add_u32 m0, m0, 896
  s_nop 0
  buffer_load_dwordx4 v8, s[52:55], s14 offen offset:128 sc1 lds
  s_add_u32 s14, s14, 256
  v_mfma_f32_32x32x16_bf16 v[64:79], v[32:35], v[128:131], v[64:79]
  v_mfma_f32_32x32x16_bf16 v[80:95], v[32:35], v[132:135], v[80:95]
  v_mfma_f32_32x32x16_bf16 v[96:111], v[36:39], v[128:131], v[96:111]
  v_mfma_f32_32x32x16_bf16 v[112:127], v[36:39], v[132:135], v[112:127]
  buffer_load_dwordx4 v[128:131], v4, s[52:55], s15 offen sc1
  buffer_load_dwordx4 v[132:135], v5, s[52:55], s15 offen sc1
  s_add_u32 s15, s15, 1024
  s_waitcnt vmcnt(8) lgkmcnt(0)
  ds_read_b64_tr_b16 v[32:33], v6 offset:4096
  ds_read_b64_tr_b16 v[34:35], v6 offset:4608
  ds_read_b64_tr_b16 v[36:37], v7 offset:4096
  ds_read_b64_tr_b16 v[38:39], v7 offset:4608
  s_add_u32 m0, s13, 2048
  s_nop 0
  buffer_load_dwordx4 v8, s[52:55], s14 offen sc1 lds
  s_add_u32 m0, m0, 896
  s_nop 0
  buffer_load_dwordx4 v8, s[52:55], s14 offen offset:128 sc1 lds
  s_add_u32 s14, s14, 256
  v_mfma_f32_32x32x16_bf16 v[64:79], v[40:43], v[136:139], v[64:79]
  v_mfma_f32_32x32x16_bf16 v[80:95], v[40:43], v[140:143], v[80:95]
  v_mfma_f32_32x32x16_bf16 v[96:111], v[44:47], v[136:139], v[96:111]
  v_mfma_f32_32x32x16_bf16 v[112:127], v[44:47], v[140:143], v[112:127]
  buffer_load_dwordx4 v[136:139], v4, s[52:55], s15 offen sc1
  buffer_load_dwordx4 v[140:143], v5, s[52:55], s15 offen sc1
  s_add_u32 s15, s15, 1024
  s_waitcnt vmcnt(8) lgkmcnt(0)
  ds_read_b64_tr_b16 v[40:41], v6 offset:6144
  ds_read_b64_tr_b16 v[42:43], v6 offset:6656
  ds_read_b64_tr_b16 v[44:45], v7 offset:6144
  ds_read_b64_tr_b16 v[46:47], v7 offset:6656
  s_add_u32 m0, s13, 4096
  s_nop 0
  buffer_load_dwordx4 v8, s[52:55], s14 offen sc1 lds
  s_add_u32 m0, m0, 896
  s_nop 0
  buffer_load_dwordx4 v8, s[52:55], s14 offen offset:128 sc1 lds
  s_add_u32 s14, s14, 256
  v_mfma_f32_32x32x16_bf16 v[64:79], v[32:35], v[144:147], v[64:79]
  v_mfma_f32_32x32x16_bf16 v[80:95], v[32:35], v[148:151], v[80:95]
  v_mfma_f32_32x32x16_bf16 v[96:111], v[36:39], v[144:147], v[96:111]
  v_mfma_f32_32x32x16_bf16 v[112:127], v[36:39], v[148:151], v[112:127]
  buffer_load_dwordx4 v[144:147], v4, s[52:55], s15 offen sc1
  buffer_load_dwordx4 v[148:151], v5, s[52:55], s15 offen sc1
  s_add_u32 s15, s15, 1024
  s_waitcnt vmcnt(8) lgkmcnt(0)
  ds_read_b64_tr_b16 v[32:33], v10 offset:0
  ds_read_b64_tr_b16 v[34:35], v11 offset:0
  ds_read_b64_tr_b16 v[36:37], v12 offset:0
  ds_read_b64_tr_b16 v[38:39], v13 offset:0
  s_add_u32 m0, s13, 6144
  s_nop 0
  buffer_load_dwordx4 v8, s[52:55], s14 offen sc1 lds
  s_add_u32 m0, m0, 896
  s_nop 0
  buffer_load_dwordx4 v8, s[52:55], s14 offen offset:128 sc1 lds
  s_add_u32 s14, s14, 256
  v_mfma_f32_32x32x16_bf16 v[64:79], v[40:43], v[152:155], v[64:79]
  v_mfma_f32_32x32x16_bf16 v[80:95], v[40:43], v[156:159], v[80:95]
  v_mfma_f32_32x32x16_bf16 v[96:111], v[44:47], v[152:155], v[96:111]
  v_mfma_f32_32x32x16_bf16 v[112:127], v[44:47], v[156:159], v[112:127]
  buffer_load_dwordx4 v[152:155], v4, s[52:55], s15 offen sc1
  buffer_load_dwordx4 v[156:159], v5, s[52:55], s15 offen sc1
  s_add_u32 s15, s15, 1024
  s_waitcnt vmcnt(8) lgkmcnt(0)
  ds_read_b64_tr_b16 v[40:41], v10 offset:2048
  ds_read_b64_tr_b16 v[42:43], v11 offset:2048
  ds_read_b64_tr_b16 v[44:45], v12 offset:2048
  ds_read_b64_tr_b16 v[46:47], v13 offset:2048
  s_add_u32 m0, s13, 0
  s_nop 0
  buffer_load_dwordx4 v8, s[52:55], s14 offen sc1 lds
  s_add_u32 m0, m0, 896
  s_nop 0
  buffer_load_dwordx4 v8, s[52:55], s14 offen offset:128 sc1 lds
  s_add_u32 s14, s14, 256
  v_mfma_f32_32x32x16_bf16 v[64:79], v[32:35], v[128:131], v[64:79]
  v_mfma_f32_32x32x16_bf16 v[80:95], v[32:35], v[132:135], v[80:95]
  v_mfma_f32_32x32x16_bf16 v[96:111], v[36:39], v[128:131], v[96:111]
  v_mfma_f32_32x32x16_bf16 v[112:127], v[36:39], v[132:135], v[112:127]
  buffer_load_dwordx4 v[128:131], v4, s[52:55], s15 offen sc1
  buffer_load_dwordx4 v[132:135], v5, s[52:55], s15 offen sc1
  s_add_u32 s15, s15, 1024
  s_waitcnt vmcnt(8) lgkmcnt(0)
  ds_read_b64_tr_b16 v[32:33], v10 offset:4096
  ds_read_b64_tr_b16 v[34:35], v11 offset:4096
  ds_read_b64_tr_b16 v[36:37], v12 offset:4096
  ds_read_b64_tr_b16 v[38:39], v13 offset:4096
  s_add_u32 m0, s13, 2048
  s_nop 0
  buffer_load_dwordx4 v8, s[52:55], s14 offen sc1 lds
  s_add_u32 m0, m0, 896
  s_nop 0
  buffer_load_dwordx4 v8, s[52:55], s14 offen offset:128 sc1 lds
  s_add_u32 s14, s14, 256
  v_mfma_f32_32x32x16_bf16 v[64:79], v[40:43], v[136:139], v[64:79]
  v_mfma_f32_32x32x16_bf16 v[80:95], v[40:43], v[140:143], v[80:95]
  v_mfma_f32_32x32x16_bf16 v[96:111], v[44:47], v[136:139], v[96:111]
  v_mfma_f32_32x32x16_bf16 v[112:127], v[44:47], v[140:143], v[112:127]
  buffer_load_dwordx4 v[136:139], v4, s[52:55], s15 offen sc1
  buffer_load_dwordx4 v[140:143], v5, s[52:55], s15 offen sc1
  s_add_u32 s15, s15, 1024
  s_waitcnt vmcnt(8) lgkmcnt(0)
  ds_read_b64_tr_b16 v[40:41], v10 offset:6144
  ds_read_b64_tr_b16 v[42:43], v11 offset:6144
  ds_read_b64_tr_b16 v[44:45], v12 offset:6144
  ds_read_b64_tr_b16 v[46:47], v13 offset:6144
  s_add_u32 m0, s13, 4096
  s_nop 0
  buffer_load_dwordx4 v8, s[52:55], s14 offen sc1 lds
  s_add_u32 m0, m0, 896
  s_nop 0
  buffer_load_dwordx4 v8, s[52:55], s14 offen offset:128 sc1 lds
  s_add_u32 s14, s14, 256
  v_mfma_f32_32x32x16_bf16 v[64:79], v[32:35], v[144:147], v[64:79]
  v_mfma_f32_32x32x16_bf16 v[80:95], v[32:35], v[148:151], v[80:95]
  v_mfma_f32_32x32x16_bf16 v[96:111], v[36:39], v[144:147], v[96:111]
  v_mfma_f32_32x32x16_bf16 v[112:127], v[36:39], v[148:151], v[112:127]
  buffer_load_dwordx4 v[144:147], v4, s[52:55], s15 offen sc1
  buffer_load_dwordx4 v[148:151], v5, s[52:55], s15 offen sc1
  s_add_u32 s15, s15, 1024
  s_waitcnt vmcnt(8) lgkmcnt(0)
  ds_read_b64_tr_b16 v[32:33], v10 offset:0
  ds_read_b64_tr_b16 v[34:35], v11 offset:0
  ds_read_b64_tr_b16 v[36:37], v12 offset:0
  ds_read_b64_tr_b16 v[38:39], v13 offset:0
  s_add_u32 m0, s13, 6144
  s_nop 0
  buffer_load_dwordx4 v8, s[52:55], s14 offen sc1 lds
  s_add_u32 m0, m0, 896
  s_nop 0
  buffer_load_dwordx4 v8, s[52:55], s14 offen offset:128 sc1 lds
  s_add_u32 s14, s14, 256
  v_mfma_f32_32x32x16_bf16 v[64:79], v[40:43], v[152:155], v[64:79]
  v_mfma_f32_32x32x16_bf16 v[80:95], v[40:43], v[156:159], v[80:95]
  v_mfma_f32_32x32x16_bf16 v[96:111], v[44:47], v[152:155], v[96:111]
  v_mfma_f32_32x32x16_bf16 v[112:127], v[44:47], v[156:159], v[112:127]
  buffer_load_dwordx4 v[152:155], v4, s[52:55], s15 offen sc1
  buffer_load_dwordx4 v[156:159], v5, s[52:55], s15 offen sc1
  s_add_u32 s15, s15, 1024
  s_waitcnt vmcnt(8) lgkmcnt(0)
  ds_read_b64_tr_b16 v[40:41], v10 offset:2048
  ds_read_b64_tr_b16 v[42:43], v11 offset:2048
  ds_read_b64_tr_b16 v[44:45], v12 offset:2048
  ds_read_b64_tr_b16 v[46:47], v13 offset:2048
  s_add_u32 m0, s13, 0
  s_nop 0
  buffer_load_dwordx4 v8, s[52:55], s14 offen sc1 lds
  s_add_u32 m0, m0, 896
  s_nop 0
  buffer_load_dwordx4 v8, s[52:55], s14 offen offset:128 sc1 lds
  s_add_u32 s14, s14, 256
  v_mfma_f32_32x32x16_bf16 v[64:79], v[32:35], v[128:131], v[64:79]
  v_mfma_f32_32x32x16_bf16 v[80:95], v[32:35], v[132:135], v[80:95]
  v_mfma_f32_32x32x16_bf16 v[96:111], v[36:39], v[128:131], v[96:111]
  v_mfma_f32_32x32x16_bf16 v[112:127], v[36:39], v[132:135], v[112:127]
  buffer_load_dwordx4 v[128:131], v4, s[52:55], s15 offen sc1
  buffer_load_dwordx4 v[132:135], v5, s[52:55], s15 offen sc1
  s_add_u32 s15, s15, 1024
  s_waitcnt vmcnt(8) lgkmcnt(0)
  ds_read_b64_tr_b16 v[32:33], v10 offset:4096
  ds_read_b64_tr_b16 v[34:35], v11 offset:4096
  ds_read_b64_tr_b16 v[36:37], v12 offset:4096
  ds_read_b64_tr_b16 v[38:39], v13 offset:4096
  s_add_u32 m0, s13, 2048
  s_nop 0
  buffer_load_dwordx4 v8, s[52:55], s14 offen sc1 lds
  s_add_u32 m0, m0, 896
  s_nop 0
  buffer_load_dwordx4 v8, s[52:55], s14 offen offset:128 sc1 lds
  s_add_u32 s14, s14, 256
  v_mfma_f32_32x32x16_bf16 v[64:79], v[40:43], v[136:139], v[64:79]
  v_mfma_f32_32x32x16_bf16 v[80:95], v[40:43], v[140:143], v[80:95]
  v_mfma_f32_32x32x16_bf16 v[96:111], v[44:47], v[136:139], v[96:111]
  v_mfma_f32_32x32x16_bf16 v[112:127], v[44:47], v[140:143], v[112:127]
  buffer_load_dwordx4 v[136:139], v4, s[52:55], s15 offen sc1
  buffer_load_dwordx4 v[140:143], v5, s[52:55], s15 offen sc1
  s_add_u32 s15, s15, 1024
  s_waitcnt vmcnt(8) lgkmcnt(0)
  ds_read_b64_tr_b16 v[40:41], v10 offset:6144
  ds_read_b64_tr_b16 v[42:43], v11 offset:6144
  ds_read_b64_tr_b16 v[44:45], v12 offset:6144
  ds_read_b64_tr_b16 v[46:47], v13 offset:6144
  s_add_u32 m0, s13, 4096
  s_nop 0
  buffer_load_dwordx4 v8, s[52:55], s14 offen sc1 lds
  s_add_u32 m0, m0, 896
  s_nop 0
  buffer_load_dwordx4 v8, s[52:55], s14 offen offset:128 sc1 lds
  s_add_u32 s14, s14, 256
  v_mfma_f32_32x32x16_bf16 v[64:79], v[32:35], v[144:147], v[64:79]
  v_mfma_f32_32x32x16_bf16 v[80:95], v[32:35], v[148:151], v[80:95]
  v_mfma_f32_32x32x16_bf16 v[96:111], v[36:39], v[144:147], v[96:111]
  v_mfma_f32_32x32x16_bf16 v[112:127], v[36:39], v[148:151], v[112:127]
  buffer_load_dwordx4 v[144:147], v4, s[52:55], s15 offen sc1
  buffer_load_dwordx4 v[148:151], v5, s[52:55], s15 offen sc1
  s_add_u32 s15, s15, 1024
  v_lshrrev_b32 v30, 5, v1
  v_mul_u32_u24 v30, 7168, v30
  v_and_b32 v31, 31, v1
  v_lshl_add_u32 v30, v31, 2, v30
  s_lshl_b32 s72, s6, 6
  s_lshl_b32 s50, s3, 4
  s_add_u32 s72, s72, s50
  s_mul_i32 s72, s72, 1792
  s_lshl_b32 s50, s7, 8
  s_add_u32 s72, s72, s50
  s_waitcnt vmcnt(8) lgkmcnt(0)
  ds_read_b64_tr_b16 v[32:33], v10 offset:0
  ds_read_b64_tr_b16 v[34:35], v11 offset:0
  ds_read_b64_tr_b16 v[36:37], v12 offset:0
  ds_read_b64_tr_b16 v[38:39], v13 offset:0
  s_add_u32 m0, s13, 6144
  s_nop 0
  buffer_load_dwordx4 v8, s[52:55], s14 offen sc1 lds
  s_add_u32 m0, m0, 896
  s_nop 0
  buffer_load_dwordx4 v8, s[52:55], s14 offen offset:128 sc1 lds
  s_add_u32 s14, s14, 256
  v_mfma_f32_32x32x16_bf16 v[64:79], v[40:43], v[152:155], v[64:79]
  v_mfma_f32_32x32x16_bf16 v[80:95], v[40:43], v[156:159], v[80:95]
  v_mfma_f32_32x32x16_bf16 v[96:111], v[44:47], v[152:155], v[96:111]
  v_mfma_f32_32x32x16_bf16 v[112:127], v[44:47], v[156:159], v[112:127]
  buffer_load_dwordx4 v[152:155], v4, s[52:55], s15 offen sc1
  buffer_load_dwordx4 v[156:159], v5, s[52:55], s15 offen sc1
  s_add_u32 s15, s15, 1024
  s_waitcnt vmcnt(8) lgkmcnt(0)
  ds_read_b64_tr_b16 v[40:41], v10 offset:2048
  ds_read_b64_tr_b16 v[42:43], v11 offset:2048
  ds_read_b64_tr_b16 v[44:45], v12 offset:2048
  ds_read_b64_tr_b16 v[46:47], v13 offset:2048
  s_add_u32 m0, s13, 0
  s_nop 0
  buffer_load_dwordx4 v8, s[52:55], s14 offen sc1 lds
  s_add_u32 m0, m0, 896
  s_nop 0
  buffer_load_dwordx4 v8, s[52:55], s14 offen offset:128 sc1 lds
  s_add_u32 s14, s14, 256
  v_mfma_f32_32x32x16_bf16 v[64:79], v[32:35], v[128:131], v[64:79]
  v_mfma_f32_32x32x16_bf16 v[80:95], v[32:35], v[132:135], v[80:95]
  v_mfma_f32_32x32x16_bf16 v[96:111], v[36:39], v[128:131], v[96:111]
  v_mfma_f32_32x32x16_bf16 v[112:127], v[36:39], v[132:135], v[112:127]
  buffer_load_dwordx4 v[128:131], v4, s[52:55], s15 offen sc1
  buffer_load_dwordx4 v[132:135], v5, s[52:55], s15 offen sc1
  s_add_u32 s15, s15, 1024
  s_waitcnt vmcnt(8) lgkmcnt(0)
  ds_read_b64_tr_b16 v[32:33], v10 offset:4096
  ds_read_b64_tr_b16 v[34:35], v11 offset:4096
  ds_read_b64_tr_b16 v[36:37], v12 offset:4096
  ds_read_b64_tr_b16 v[38:39], v13 offset:4096
  s_add_u32 m0, s13, 2048
  s_nop 0
  buffer_load_dwordx4 v8, s[52:55], s14 offen sc1 lds
  s_add_u32 m0, m0, 896
  s_nop 0
  buffer_load_dwordx4 v8, s[52:55], s14 offen offset:128 sc1 lds
  s_add_u32 s14, s14, 256
  v_mfma_f32_32x32x16_bf16 v[64:79], v[40:43], v[136:139], v[64:79]
  v_mfma_f32_32x32x16_bf16 v[80:95], v[40:43], v[140:143], v[80:95]
  v_mfma_f32_32x32x16_bf16 v[96:111], v[44:47], v[136:139], v[96:111]
  v_mfma_f32_32x32x16_bf16 v[112:127], v[44:47], v[140:143], v[112:127]
  buffer_load_dwordx4 v[136:139], v4, s[52:55], s15 offen sc1
  buffer_load_dwordx4 v[140:143], v5, s[52:55], s15 offen sc1
  s_add_u32 s15, s15, 1024
  s_waitcnt vmcnt(8) lgkmcnt(0)
  ds_read_b64_tr_b16 v[40:41], v10 offset:6144
  ds_read_b64_tr_b16 v[42:43], v11 offset:6144
  ds_read_b64_tr_b16 v[44:45], v12 offset:6144
  ds_read_b64_tr_b16 v[46:47], v13 offset:6144
  v_mfma_f32_32x32x16_bf16 v[64:79], v[32:35], v[144:147], v[64:79]
  v_mfma_f32_32x32x16_bf16 v[80:95], v[32:35], v[148:151], v[80:95]
  v_mfma_f32_32x32x16_bf16 v[96:111], v[36:39], v[144:147], v[96:111]
  v_mfma_f32_32x32x16_bf16 v[112:127], v[36:39], v[148:151], v[112:127]
  s_waitcnt vmcnt(4) lgkmcnt(0)
  ds_read_b64_tr_b16 v[32:33], v10 offset:0
  ds_read_b64_tr_b16 v[34:35], v11 offset:0
  ds_read_b64_tr_b16 v[36:37], v12 offset:0
  ds_read_b64_tr_b16 v[38:39], v13 offset:0
  v_mfma_f32_32x32x16_bf16 v[64:79], v[40:43], v[152:155], v[64:79]
  v_mfma_f32_32x32x16_bf16 v[80:95], v[40:43], v[156:159], v[80:95]
  v_mfma_f32_32x32x16_bf16 v[96:111], v[44:47], v[152:155], v[96:111]
  v_mfma_f32_32x32x16_bf16 v[112:127], v[44:47], v[156:159], v[112:127]
  s_waitcnt vmcnt(0) lgkmcnt(0)
  ds_read_b64_tr_b16 v[40:41], v10 offset:2048
  ds_read_b64_tr_b16 v[42:43], v11 offset:2048
  ds_read_b64_tr_b16 v[44:45], v12 offset:2048
  ds_read_b64_tr_b16 v[46:47], v13 offset:2048
  v_mfma_f32_32x32x16_bf16 v[64:79], v[32:35], v[128:131], v[64:79]
  v_mfma_f32_32x32x16_bf16 v[80:95], v[32:35], v[132:135], v[80:95]
  v_mfma_f32_32x32x16_bf16 v[96:111], v[36:39], v[128:131], v[96:111]
  v_mfma_f32_32x32x16_bf16 v[112:127], v[36:39], v[132:135], v[112:127]
  s_waitcnt lgkmcnt(0)
  v_mfma_f32_32x32x16_bf16 v[64:79], v[40:43], v[136:139], v[64:79]
  v_mfma_f32_32x32x16_bf16 v[80:95], v[40:43], v[140:143], v[80:95]
  v_mfma_f32_32x32x16_bf16 v[96:111], v[44:47], v[136:139], v[96:111]
  v_mfma_f32_32x32x16_bf16 v[112:127], v[44:47], v[140:143], v[112:127]
  s_nop 10
  ds_write_b128 v24, v[72:75] offset:0
  ds_write_b128 v24, v[76:79] offset:1024
  ds_write_b128 v24, v[88:91] offset:2048
  ds_write_b128 v24, v[92:95] offset:3072
  ds_write_b128 v25, v[96:99] offset:0
  ds_write_b128 v25, v[100:103] offset:1024
  ds_write_b128 v25, v[112:115] offset:2048
  ds_write_b128 v25, v[116:119] offset:3072
  ds_write_b128 v26, v[104:107] offset:0
  ds_write_b128 v26, v[108:111] offset:1024
  ds_write_b128 v26, v[120:123] offset:2048
  ds_write_b128 v26, v[124:127] offset:3072
  s_waitcnt lgkmcnt(0)
  s_barrier
  ds_read_b128 v[192:195], v27 offset:0
  ds_read_b128 v[196:199], v27 offset:1024
  ds_read_b128 v[200:203], v27 offset:2048
  ds_read_b128 v[204:207], v27 offset:3072
  ds_read_b128 v[208:211], v28 offset:0
  ds_read_b128 v[212:215], v28 offset:1024
  ds_read_b128 v[216:219], v28 offset:2048
  ds_read_b128 v[220:223], v28 offset:3072
  ds_read_b128 v[224:227], v29 offset:0
  ds_read_b128 v[228:231], v29 offset:1024
  ds_read_b128 v[232:235], v29 offset:2048
  ds_read_b128 v[236:239], v29 offset:3072
  s_waitcnt lgkmcnt(8)
  v_pk_add_f32 v[64:65], v[64:65], v[192:193]
  v_pk_add_f32 v[66:67], v[66:67], v[194:195]
  v_pk_add_f32 v[68:69], v[68:69], v[196:197]
  v_pk_add_f32 v[70:71], v[70:71], v[198:199]
  v_pk_add_f32 v[80:81], v[80:81], v[200:201]
  v_pk_add_f32 v[82:83], v[82:83], v[202:203]
  v_pk_add_f32 v[84:85], v[84:85], v[204:205]
  v_pk_add_f32 v[86:87], v[86:87], v[206:207]
  s_waitcnt lgkmcnt(4)
  v_pk_add_f32 v[64:65], v[64:65], v[208:209]
  v_pk_add_f32 v[66:67], v[66:67], v[210:211]
  v_pk_add_f32 v[68:69], v[68:69], v[212:213]
  v_pk_add_f32 v[70:71], v[70:71], v[214:215]
  v_pk_add_f32 v[80:81], v[80:81], v[216:217]
  v_pk_add_f32 v[82:83], v[82:83], v[218:219]
  v_pk_add_f32 v[84:85], v[84:85], v[220:221]
  v_pk_add_f32 v[86:87], v[86:87], v[222:223]
  s_waitcnt lgkmcnt(0)
  v_pk_add_f32 v[64:65], v[64:65], v[224:225]
  v_pk_add_f32 v[66:67], v[66:67], v[226:227]
  v_pk_add_f32 v[68:69], v[68:69], v[228:229]
  v_pk_add_f32 v[70:71], v[70:71], v[230:231]
  v_pk_add_f32 v[80:81], v[80:81], v[232:233]
  v_pk_add_f32 v[82:83], v[82:83], v[234:235]
  v_pk_add_f32 v[84:85], v[84:85], v[236:237]
  v_pk_add_f32 v[86:87], v[86:87], v[238:239]
  s_add_u32 s50, s72, 0
  buffer_store_dword v64, v30, s[64:67], s50 offen offset:0 nt
  buffer_store_dword v80, v30, s[64:67], s50 offen offset:128 nt
  s_add_u32 s50, s72, 1792
  buffer_store_dword v65, v30, s[64:67], s50 offen offset:0 nt
  buffer_store_dword v81, v30, s[64:67], s50 offen offset:128 nt
  s_add_u32 s50, s72, 3584
  buffer_store_dword v66, v30, s[64:67], s50 offen offset:0 nt
  buffer_store_dword v82, v30, s[64:67], s50 offen offset:128 nt
  s_add_u32 s50, s72, 5376
  buffer_store_dword v67, v30, s[64:67], s50 offen offset:0 nt
  buffer_store_dword v83, v30, s[64:67], s50 offen offset:128 nt
  s_add_u32 s50, s72, 14336
  buffer_store_dword v68, v30, s[64:67], s50 offen offset:0 nt
  buffer_store_dword v84, v30, s[64:67], s50 offen offset:128 nt
  s_add_u32 s50, s72, 16128
  buffer_store_dword v69, v30, s[64:67], s50 offen offset:0 nt
  buffer_store_dword v85, v30, s[64:67], s50 offen offset:128 nt
  s_add_u32 s50, s72, 17920
  buffer_store_dword v70, v30, s[64:67], s50 offen offset:0 nt
  buffer_store_dword v86, v30, s[64:67], s50 offen offset:128 nt
  s_add_u32 s50, s72, 19712
  buffer_store_dword v71, v30, s[64:67], s50 offen offset:0 nt
  buffer_store_dword v87, v30, s[64:67], s50 offen offset:128 nt
L_fin:
L_end:
  s_endpgm
L_helper:
  s_sub_u32 s3, s3, 4
  s_mov_b32 s68, s36
  s_and_b32 s69, s37, 0xffff
  s_mov_b32 s70, 7340032
  s_mov_b32 s71, 0x20000
  s_mul_i32 s74, s4, 7
  s_lshr_b32 s74, s74, 1
  s_lshl_b32 s74, s74, 7
  s_lshl_b32 s50, s5, 6
  s_lshl_b32 s51, s3, 4
  s_add_u32 s50, s50, s51
  s_mul_i32 s50, s50, 3584
  s_add_u32 s50, s50, s74
  v_lshrrev_b32 v254, 2, v1
  v_mul_u32_u24 v254, 3584, v254
  v_and_b32 v253, 3, v1
  v_lshl_add_u32 v254, v253, 7, v254
  buffer_load_dword v255, v254, s[68:71], s50 offen
  s_cmp_lt_u32 s5, 7
  s_mov_b32 s51, 2147483648
  s_cselect_b32 s50, 5734400, s51
  s_lshl_b32 s51, s5, 2
  s_add_u32 s51, s51, s3
  s_mul_i32 s51, s51, 57344
  s_add_u32 s50, s50, s51
  s_add_u32 s50, s50, s74
  buffer_load_dword v255, v254, s[68:71], s50 offen
  s_endpgm
.section .rodata,"a"
.p2align 6
.amdhsa_kernel parallel_sum__ssm_conv_s5__mixer_token_mlp__prompt_kernel
  .amdhsa_next_free_vgpr 256
  .amdhsa_next_free_sgpr 102
  .amdhsa_accum_offset 256
  .amdhsa_group_segment_fixed_size 0
  .amdhsa_kernarg_size 136
  .amdhsa_user_sgpr_count 2
  .amdhsa_user_sgpr_kernarg_segment_ptr 1
  .amdhsa_system_sgpr_workgroup_id_x 1
  .amdhsa_float_denorm_mode_32 3
.end_amdhsa_kernel
```
